```python
import torch

def _softmax(x, axis=-1):
    return torch.softmax(x, dim=axis)
def _gelu(x):
    return torch.nn.functional.gelu(x, approximate="tanh")
def _silu(x):
    return torch.nn.functional.silu(x)
def _sigmoid(x):
    return torch.sigmoid(x)
def _layernorm(x, axis=-1, eps=1e-5):
    m = x.mean(dim=axis, keepdim=True)
    v = x.var(dim=axis, keepdim=True, unbiased=False)
    return (x - m) / torch.sqrt(v + eps)
def _scatter_add(tgt, idx, src, axis=0):
    return tgt.clone().index_add_(axis, idx, src)
def _segment_sum(src, seg, n):
    out = torch.zeros((n,) + src.shape[1:], dtype=src.dtype)
    return out.index_add_(0, seg, src)
def _pad(x, pw):
    flat = tuple(v for pair in reversed(pw) for v in pair)
    return torch.nn.functional.pad(x, flat)

kernel_name = 'interleave_layers__sliding_local_dilated__sliding_block__prompt'

def setup_inputs():

    _w = (lambda a: (lambda t: t.to(torch.bfloat16) if t.is_floating_point() else t)(torch.as_tensor(a)))
    def _A_setup():
        B, S, D = 1, 2048, 640
        return {
            "x": _w((lambda *s: torch.randn(*s, dtype=torch.bfloat16) * 0.05)(B, S, D)),
            "wqkv": _w((lambda *s: torch.randn(*s, dtype=torch.bfloat16) * 0.05)(D, 3 * D)),
            "wo": _w((lambda *s: torch.randn(*s, dtype=torch.bfloat16) * 0.05)(D, D)),
        }
    _A_in = _A_setup()

    def _B_setup():
        B, S, D = 1, 2048, 640
        return {
            "x": _w((lambda *s: torch.randn(*s, dtype=torch.bfloat16) * 0.05)(B, S, D)),
            "wqkv": _w((lambda *s: torch.randn(*s, dtype=torch.bfloat16) * 0.05)(D, 3 * D)),
            "wo": _w((lambda *s: torch.randn(*s, dtype=torch.bfloat16) * 0.05)(D, D)),
        }
    _B_in = _B_setup()

    return {
        "A_x": _A_in["x"],
        "A_wqkv": _A_in["wqkv"],
        "A_wo": _A_in["wo"],
        "B_x": _B_in["x"],
        "B_wqkv": _B_in["wqkv"],
        "B_wo": _B_in["wo"],
    }

def reference(A_x, A_wqkv, A_wo, B_x, B_wqkv, B_wo):
    def _A_ref(x, wqkv, wo):
        B, S, D = x.shape
        H = 32; Dh = D // H
        W, dil = 8, 2
        qkv = (lambda x, *d: x.permute(*d))((x @ wqkv).reshape(B, S, 3, H, Dh), 2, 0, 3, 1, 4)
        q, k, v = qkv[0], qkv[1], qkv[2]
        scale = Dh ** -0.5
        pos = torch.arange(S)
        off = torch.arange(W) * dil
        idx = pos[:, None] - off[None, :]
        mask = idx >= 0
        idx_c = torch.where(mask, idx, 0).reshape(-1)
        kg = k[:, :, idx_c, :].reshape(B, H, S, W, Dh)
        vg = v[:, :, idx_c, :].reshape(B, H, S, W, Dh)
        logits = torch.einsum("bhsd,bhswd->bhsw", q, kg) * scale
        logits = torch.where(mask[None, None, :, :], logits, -1e9)
        attn = _softmax(logits, axis=-1)
        o = torch.einsum("bhsw,bhswd->bhsd", attn, vg)
        return (lambda x, *d: x.permute(*d))(o, 0, 2, 1, 3).reshape(B, S, D) @ wo

    def _B_ref(x, wqkv, wo):
        B, S, D = x.shape
        H = 32; Dh = D // H; W = 256
        qkv = (lambda x, *d: x.permute(*d))((x @ wqkv).reshape(B, S, 3, H, Dh), 2, 0, 3, 1, 4)
        q, k, v = qkv[0], qkv[1], qkv[2]
        scores = torch.einsum("bhqd,bhkd->bhqk", q, k) * (Dh ** -0.5)
        idx = torch.arange(S)
        mask = (idx[:, None] - idx[None, :] >= 0) & (idx[:, None] - idx[None, :] < W)
        scores = torch.where(mask[None, None], scores, -1e9)
        p = _softmax(scores, axis=-1)
        o = torch.einsum("bhqk,bhkd->bhqd", p, v)
        return (lambda x, *d: x.permute(*d))(o, 0, 2, 1, 3).reshape(B, S, D) @ wo

    x = A_x
    x = x + _A_ref(_layernorm(x, axis=-1), A_wqkv, A_wo)
    x = x + _B_ref(_layernorm(x, axis=-1), B_wqkv, B_wo)
    x = x + _A_ref(_layernorm(x, axis=-1), A_wqkv, A_wo)
    x = x + _B_ref(_layernorm(x, axis=-1), B_wqkv, B_wo)
    return x
```

```asm
; @launch grid=(256,1,1) block=(256,1,1) lds=163840
.amdgcn_target "amdgcn-amd-amdhsa--gfx950"
.text
.globl interleave_layers__sliding_local_dilated__sliding_block__prompt_kernel
.p2align 8
.type interleave_layers__sliding_local_dilated__sliding_block__prompt_kernel,@function
interleave_layers__sliding_local_dilated__sliding_block__prompt_kernel:
s_cmp_ge_u32 s2, 256
s_cbranch_scc1 L_end
s_load_dwordx16 s[40:55], s[0:1], 0
s_load_dwordx2 s[56:57], s[0:1], 64
s_getpc_b64 s[32:33]
L_pc:
s_sub_u32 s32, s32, L_pc-interleave_layers__sliding_local_dilated__sliding_block__prompt_kernel
s_subb_u32 s33, s33, 0
s_mov_b32 s34, L_codeend-interleave_layers__sliding_local_dilated__sliding_block__prompt_kernel
s_mov_b32 s35, 0x20000
v_and_b32 v2, 63, v0
v_lshlrev_b32 v2, 7, v2
s_lshr_b32 s28, s2, 3
s_and_b32 s28, s28, 7
s_lshl_b32 s28, s28, 13
buffer_load_dword v237, v2, s[32:35], s28 offen
v_lshrrev_b32 v1, 6, v0
v_and_b32 v0, 63, v0
v_readfirstlane_b32 s22, v1
s_and_b32 s3, s2, 7
s_lshr_b32 s28, s2, 3
s_lshr_b32 s29, s28, 4
s_lshl_b32 s20, s3, 1
s_add_u32 s20, s20, s29
s_and_b32 s21, s28, 15
s_and_b32 s58, s21, 1
s_lshr_b32 s59, s21, 1
s_mov_b32 s23, 0
s_mov_b32 s64, 0
s_mov_b32 s60, 0
s_mov_b32 s66, -1
s_mov_b32 s67, 0
s_mov_b32 s68, 0
s_mov_b32 s69, -1
s_bitcmp1_b32 s21, 0
s_cselect_b64 s[70:71], s[66:67], s[68:69]
s_cselect_b64 s[72:73], s[68:69], s[66:67]
s_cselect_b64 s[74:75], -1, 0
v_and_b32 v251, 31, v0
v_lshrrev_b32 v252, 5, v0
v_and_b32 v253, 15, v0
v_lshrrev_b32 v254, 4, v0
v_lshlrev_b32 v241, 4, v0
v_lshlrev_b32 v236, 7, v0
s_waitcnt lgkmcnt(0)
s_mov_b32 s12, s56
s_mov_b32 s13, s57
s_mov_b32 s14, 0x10000000
s_mov_b32 s15, 0x20000
s_load_dwordx2 s[26:27], s[56:57], 0
s_mov_b32 s16, s40
s_mov_b32 s17, s41
s_mov_b32 s18, 2621440
s_mov_b32 s19, 0x20000
v_mul_u32_u24 v1, 1280, v253
v_lshlrev_b32 v2, 3, v254
v_add_u32 v1, v1, v2
s_lshl_b32 s28, s20, 7
s_lshl_b32 s29, s58, 6
s_add_u32 s28, s28, s29
s_lshl_b32 s29, s22, 4
s_add_u32 s28, s28, s29
s_mul_i32 s28, s28, 1280
s_mul_i32 s29, s59, 160
s_add_u32 s28, s28, s29
buffer_load_dwordx2 v[16:17], v1, s[16:19], s28 offen offset:0
buffer_load_dwordx2 v[18:19], v1, s[16:19], s28 offen offset:32
buffer_load_dwordx2 v[20:21], v1, s[16:19], s28 offen offset:64
buffer_load_dwordx2 v[22:23], v1, s[16:19], s28 offen offset:96
buffer_load_dwordx2 v[24:25], v1, s[16:19], s28 offen offset:128
s_cmp_lt_u32 s22, 2
s_cselect_b32 s32, s42, s48
s_cselect_b32 s33, s43, s49
s_mov_b32 s34, 2457600
s_mov_b32 s35, 0x20000
s_lshl_b32 s28, s20, 1
s_and_b32 s29, s22, 1
s_add_u32 s28, s28, s29
s_and_b32 s90, s28, 3
s_lshr_b32 s91, s28, 2
v_and_b32 v4, 3, v0
s_lshl_b32 s28, s90, 2
v_add_u32 v4, s28, v4
v_min_u32 v4, 14, v4
v_mul_u32_u24 v6, 13, v4
v_lshrrev_b32 v6, 6, v6
v_mul_u32_u24 v5, 1200, v6
v_add_u32 v5, 1280, v5
v_cmp_eq_u32 vcc, 2, v6
v_mov_b32 v6, 3840
s_nop 0
v_cndmask_b32 v6, 0, v6, vcc
v_sub_u32 v5, v5, v6
v_lshlrev_b32 v6, 4, v4
v_add_u32 v5, v5, v6
s_mul_i32 s29, s21, 80
v_add_u32 v5, s29, v5
v_lshrrev_b32 v6, 2, v0
v_mul_u32_u24 v6, 3840, v6
v_add_u32 v5, v5, v6
s_mul_i32 s28, s91, 307200
s_mul_i32 s89, s22, 5120
s_add_u32 m0, s89, 0
s_nop 0
buffer_load_dwordx4 v5, s[32:35], s28 offen lds
s_add_u32 s28, s28, 61440
s_add_u32 m0, s89, 1024
s_nop 0
buffer_load_dwordx4 v5, s[32:35], s28 offen lds
s_add_u32 s28, s28, 61440
s_add_u32 m0, s89, 2048
s_nop 0
buffer_load_dwordx4 v5, s[32:35], s28 offen lds
s_add_u32 s28, s28, 61440
s_add_u32 m0, s89, 3072
s_nop 0
buffer_load_dwordx4 v5, s[32:35], s28 offen lds
s_add_u32 s28, s28, 61440
s_add_u32 m0, s89, 4096
s_nop 0
buffer_load_dwordx4 v5, s[32:35], s28 offen lds
v_add_u32 v2, 0, v0
v_mul_u32_u24 v3, 6554, v2
v_lshrrev_b32 v3, 16, v3
v_mul_u32_u24 v4, 10, v3
v_sub_u32 v4, v2, v4
v_mul_u32_u24 v3, 1280, v3
v_lshlrev_b32 v4, 4, v4
v_add_u32 v242, v3, v4
v_add_u32 v2, 64, v0
v_mul_u32_u24 v3, 6554, v2
v_lshrrev_b32 v3, 16, v3
v_mul_u32_u24 v4, 10, v3
v_sub_u32 v4, v2, v4
v_mul_u32_u24 v3, 1280, v3
v_lshlrev_b32 v4, 4, v4
v_add_u32 v243, v3, v4
v_add_u32 v2, 128, v0
v_mul_u32_u24 v3, 6554, v2
v_lshrrev_b32 v3, 16, v3
v_mul_u32_u24 v4, 10, v3
v_sub_u32 v4, v2, v4
v_mul_u32_u24 v3, 1280, v3
v_lshlrev_b32 v4, 4, v4
v_add_u32 v244, v3, v4
v_add_u32 v2, 192, v0
v_mul_u32_u24 v3, 6554, v2
v_lshrrev_b32 v3, 16, v3
v_mul_u32_u24 v4, 10, v3
v_sub_u32 v4, v2, v4
v_mul_u32_u24 v3, 1280, v3
v_lshlrev_b32 v4, 4, v4
v_add_u32 v245, v3, v4
v_add_u32 v2, 256, v0
v_mul_u32_u24 v3, 6554, v2
v_lshrrev_b32 v3, 16, v3
v_mul_u32_u24 v4, 10, v3
v_sub_u32 v4, v2, v4
v_mul_u32_u24 v3, 1280, v3
v_lshlrev_b32 v4, 4, v4
v_add_u32 v246, v3, v4
v_lshrrev_b32 v2, 2, v253
v_lshlrev_b32 v3, 3, v254
v_add_u32 v2, v2, v3
v_mul_u32_u24 v4, 160, v2
v_and_b32 v3, 3, v0
v_lshlrev_b32 v3, 3, v3
v_add_u32 v247, v4, v3
v_lshlrev_b32 v2, 9, v252
v_lshlrev_b32 v3, 4, v253
v_add_u32 v2, v2, v3
v_and_b32 v3, 1, v254
v_lshlrev_b32 v3, 3, v3
v_add_u32 v249, v2, v3
s_lshl_b32 s93, s20, 1
s_add_u32 s93, s93, s58
s_cmp_lt_u32 s93, 20
s_cselect_b32 s28, 0, 9
s_add_u32 s28, s28, s22
s_mov_b32 s92, 0
s_cmp_lt_u32 s28, 2
s_cselect_b32 s92, 1, 0
s_cbranch_scc0 L_nowo_1
s_cmp_eq_u32 s22, 0
s_cselect_b32 s36, s44, s50
s_cselect_b32 s37, s45, s51
s_mov_b32 s38, 819200
s_mov_b32 s39, 0x20000
s_mul_i32 s28, s93, 40960
s_mul_i32 s29, s59, 160
s_add_u32 s28, s28, s29
s_mul_i32 s29, s22, 5120
s_add_u32 s29, s29, 20480
s_add_u32 m0, s29, 0
s_nop 0
buffer_load_dwordx4 v242, s[36:39], s28 offen lds
s_add_u32 m0, s29, 1024
s_nop 0
buffer_load_dwordx4 v243, s[36:39], s28 offen lds
s_add_u32 m0, s29, 2048
s_nop 0
buffer_load_dwordx4 v244, s[36:39], s28 offen lds
s_add_u32 m0, s29, 3072
s_nop 0
buffer_load_dwordx4 v245, s[36:39], s28 offen lds
s_add_u32 m0, s29, 4096
s_nop 0
buffer_load_dwordx4 v246, s[36:39], s28 offen lds
L_nowo_1:
s_waitcnt lgkmcnt(0)
s_cmp_lg_u32 s22, 0
s_cbranch_scc1 L_w0skip_2
s_mov_b64 s[62:63], exec
s_mov_b64 exec, 1
s_mov_b32 s80, s54
s_mov_b32 s81, s55
s_mov_b32 s82, 256
s_mov_b32 s83, 0x20000
v_mov_b32 v250, 1
v_mov_b32 v6, 0
buffer_atomic_add v250, v6, s[80:83], 0 offen sc0 sc1
s_mov_b64 exec, s[62:63]
L_w0skip_2:
s_mov_b32 s76, 1048576
s_mov_b32 s77, 131072
s_waitcnt vmcnt(5)
v_lshlrev_b32 v176, 16, v16
v_and_b32 v177, 0xffff0000, v16
v_lshlrev_b32 v178, 16, v17
v_and_b32 v179, 0xffff0000, v17
v_lshlrev_b32 v180, 16, v18
v_and_b32 v181, 0xffff0000, v18
v_lshlrev_b32 v182, 16, v19
v_and_b32 v183, 0xffff0000, v19
v_lshlrev_b32 v184, 16, v20
v_and_b32 v185, 0xffff0000, v20
v_lshlrev_b32 v186, 16, v21
v_and_b32 v187, 0xffff0000, v21
v_lshlrev_b32 v188, 16, v22
v_and_b32 v189, 0xffff0000, v22
v_lshlrev_b32 v190, 16, v23
v_and_b32 v191, 0xffff0000, v23
v_lshlrev_b32 v192, 16, v24
v_and_b32 v193, 0xffff0000, v24
v_lshlrev_b32 v194, 16, v25
v_and_b32 v195, 0xffff0000, v25
s_lshl_b32 s28, s20, 2
s_lshl_b32 s29, s58, 1
s_add_u32 s28, s28, s29
s_lshr_b32 s29, s22, 1
s_add_u32 s28, s28, s29
s_mul_i32 s28, s28, 40
s_mul_i32 s29, s59, 5
s_add_u32 s28, s28, s29
s_lshl_b32 s28, s28, 10
s_and_b32 s29, s22, 1
s_lshl_b32 s29, s29, 8
s_add_u32 s28, s28, s29
s_add_u32 s28, s28, s76
s_add_u32 s29, s28, 4096
buffer_store_dwordx2 v[16:17], v249, s[12:15], s28 offen offset:0 sc1
buffer_store_dwordx2 v[18:19], v249, s[12:15], s28 offen offset:1024 sc1
buffer_store_dwordx2 v[20:21], v249, s[12:15], s28 offen offset:2048 sc1
buffer_store_dwordx2 v[22:23], v249, s[12:15], s28 offen offset:3072 sc1
buffer_store_dwordx2 v[24:25], v249, s[12:15], s29 offen offset:0 sc1
v_pk_add_f32 v[8:9], v[176:177], v[178:179]
v_pk_mul_f32 v[10:11], v[176:177], v[176:177]
v_pk_fma_f32 v[10:11], v[178:179], v[178:179], v[10:11]
v_pk_add_f32 v[8:9], v[8:9], v[180:181]
v_pk_fma_f32 v[10:11], v[180:181], v[180:181], v[10:11]
v_pk_add_f32 v[8:9], v[8:9], v[182:183]
v_pk_fma_f32 v[10:11], v[182:183], v[182:183], v[10:11]
v_pk_add_f32 v[8:9], v[8:9], v[184:185]
v_pk_fma_f32 v[10:11], v[184:185], v[184:185], v[10:11]
v_pk_add_f32 v[8:9], v[8:9], v[186:187]
v_pk_fma_f32 v[10:11], v[186:187], v[186:187], v[10:11]
v_pk_add_f32 v[8:9], v[8:9], v[188:189]
v_pk_fma_f32 v[10:11], v[188:189], v[188:189], v[10:11]
v_pk_add_f32 v[8:9], v[8:9], v[190:191]
v_pk_fma_f32 v[10:11], v[190:191], v[190:191], v[10:11]
v_pk_add_f32 v[8:9], v[8:9], v[192:193]
v_pk_fma_f32 v[10:11], v[192:193], v[192:193], v[10:11]
v_pk_add_f32 v[8:9], v[8:9], v[194:195]
v_pk_fma_f32 v[10:11], v[194:195], v[194:195], v[10:11]
v_add_f32 v8, v8, v9
v_add_f32 v9, v10, v11
v_mov_b32 v10, v8
s_nop 1
v_permlane16_swap_b32 v8, v10
v_add_f32 v8, v8, v10
v_mov_b32 v11, v9
s_nop 1
v_permlane16_swap_b32 v9, v11
v_add_f32 v9, v9, v11
v_mov_b32 v10, v8
s_nop 1
v_permlane32_swap_b32 v8, v10
v_add_f32 v8, v8, v10
v_mov_b32 v11, v9
s_nop 1
v_permlane32_swap_b32 v9, v11
v_add_f32 v9, v9, v11
s_lshl_b32 s28, s20, 1
s_add_u32 s28, s28, s58
s_lshl_b32 s28, s28, 3
s_add_u32 s28, s28, s59
s_lshl_b32 s28, s28, 9
s_lshl_b32 s29, s22, 7
s_add_u32 s28, s28, s29
s_add_u32 s28, s28, s77
v_lshlrev_b32 v10, 3, v253
s_mov_b64 s[62:63], exec
s_mov_b64 exec, 0xffff
buffer_store_dwordx2 v[8:9], v10, s[12:15], s28 offen sc1
s_mov_b64 exec, s[62:63]
s_waitcnt vmcnt(6)
v_lshrrev_b32 v2, 2, v253
v_lshlrev_b32 v3, 3, v252
v_add_u32 v2, v2, v3
v_lshlrev_b32 v2, 6, v2
v_and_b32 v3, 1, v254
v_lshlrev_b32 v3, 5, v3
v_add_u32 v2, v2, v3
v_and_b32 v3, 3, v0
v_lshlrev_b32 v3, 3, v3
v_add_u32 v2, v2, v3
v_add_u32 v2, s89, v2
ds_read_b64_tr_b16 v[96:97], v2 offset:0
ds_read_b64_tr_b16 v[98:99], v2 offset:256
ds_read_b64_tr_b16 v[100:101], v2 offset:1024
ds_read_b64_tr_b16 v[102:103], v2 offset:1280
ds_read_b64_tr_b16 v[104:105], v2 offset:2048
ds_read_b64_tr_b16 v[106:107], v2 offset:2304
ds_read_b64_tr_b16 v[108:109], v2 offset:3072
ds_read_b64_tr_b16 v[110:111], v2 offset:3328
ds_read_b64_tr_b16 v[112:113], v2 offset:4096
ds_read_b64_tr_b16 v[114:115], v2 offset:4352
v_mul_u32_u24 v3, 384, v252
v_lshlrev_b32 v4, 4, v251
v_add_u32 v3, v3, v4
v_cmp_gt_u32 vcc, 24, v251
v_mov_b32 v4, 0x7fff0000
s_nop 0
v_cndmask_b32 v3, v4, v3, vcc
s_cmp_eq_u32 s90, 3
s_cselect_b64 s[32:33], -1, 0
v_cndmask_b32 v3, v241, v3, s[32:33]
s_movk_i32 s88, 1024
s_cselect_b32 s88, 768, s88
s_mul_i32 s28, s90, 40960
s_mul_i32 s29, s91, 5
s_mul_i32 s29, s29, s88
s_add_u32 s87, s28, s29
s_lshr_b32 s28, s22, 1
s_mul_i32 s28, s28, 0x280000
s_mul_i32 s29, s21, 0x28000
s_add_u32 s28, s28, s29
s_add_u32 s28, s28, 52428800
s_add_u32 s32, s56, s28
s_addc_u32 s33, s57, 0
s_mov_b32 s34, 153600
s_mov_b32 s35, 0x20000
v_mov_b32 v120, 0
v_mov_b32 v121, 0x3f803f80
s_waitcnt lgkmcnt(0)
buffer_store_dwordx4 v[96:99], v3, s[32:35], s87 offen sc1
s_add_u32 s87, s87, s88
buffer_store_dwordx4 v[100:103], v3, s[32:35], s87 offen sc1
s_add_u32 s87, s87, s88
buffer_store_dwordx4 v[104:107], v3, s[32:35], s87 offen sc1
s_add_u32 s87, s87, s88
buffer_store_dwordx4 v[108:111], v3, s[32:35], s87 offen sc1
s_add_u32 s87, s87, s88
buffer_store_dwordx4 v[112:115], v3, s[32:35], s87 offen sc1
v_dot2c_f32_bf16 v120, v96, v121
v_dot2c_f32_bf16 v120, v97, v121
v_dot2c_f32_bf16 v120, v98, v121
v_dot2c_f32_bf16 v120, v99, v121
v_dot2c_f32_bf16 v120, v100, v121
v_dot2c_f32_bf16 v120, v101, v121
v_dot2c_f32_bf16 v120, v102, v121
v_dot2c_f32_bf16 v120, v103, v121
v_dot2c_f32_bf16 v120, v104, v121
v_dot2c_f32_bf16 v120, v105, v121
v_dot2c_f32_bf16 v120, v106, v121
v_dot2c_f32_bf16 v120, v107, v121
v_dot2c_f32_bf16 v120, v108, v121
v_dot2c_f32_bf16 v120, v109, v121
v_dot2c_f32_bf16 v120, v110, v121
v_dot2c_f32_bf16 v120, v111, v121
v_dot2c_f32_bf16 v120, v112, v121
v_dot2c_f32_bf16 v120, v113, v121
v_dot2c_f32_bf16 v120, v114, v121
v_dot2c_f32_bf16 v120, v115, v121
s_nop 2
v_mov_b32 v122, v120
s_nop 1
v_permlane32_swap_b32 v120, v122
v_add_f32 v120, v120, v122
s_lshr_b32 s28, s22, 1
s_lshl_b32 s28, s28, 4
s_add_u32 s28, s28, s21
s_lshl_b32 s28, s28, 3
s_add_u32 s28, s28, s91
s_lshl_b32 s28, s28, 9
s_lshl_b32 s29, s90, 7
s_add_u32 s28, s28, s29
s_add_u32 s28, s28, 655360
v_lshlrev_b32 v2, 2, v251
buffer_store_dword v120, v2, s[12:15], s28 offen sc1
s_cmp_eq_u32 s92, 0
s_cbranch_scc1 L_nowo2_3
s_mul_i32 s29, s22, 5120
s_add_u32 s29, s29, 20480
v_add_u32 v2, s29, v247
ds_read_b64_tr_b16 v[124:125], v2 offset:0
ds_read_b64_tr_b16 v[126:127], v2 offset:640
ds_read_b64_tr_b16 v[128:129], v2 offset:32
ds_read_b64_tr_b16 v[130:131], v2 offset:672
ds_read_b64_tr_b16 v[132:133], v2 offset:64
ds_read_b64_tr_b16 v[134:135], v2 offset:704
ds_read_b64_tr_b16 v[136:137], v2 offset:96
ds_read_b64_tr_b16 v[138:139], v2 offset:736
ds_read_b64_tr_b16 v[140:141], v2 offset:128
ds_read_b64_tr_b16 v[142:143], v2 offset:768
s_lshl_b32 s28, s22, 3
s_add_u32 s28, s28, s59
s_mul_i32 s28, s28, 0x19000
s_mul_i32 s29, s93, 5120
s_add_u32 s28, s28, s29
s_add_u32 s28, s28, 58720256
s_add_u32 s29, s28, 4096
s_waitcnt lgkmcnt(0)
buffer_store_dwordx4 v[124:127], v241, s[12:15], s28 offen offset:0 sc1
buffer_store_dwordx4 v[128:131], v241, s[12:15], s28 offen offset:1024 sc1
buffer_store_dwordx4 v[132:135], v241, s[12:15], s28 offen offset:2048 sc1
buffer_store_dwordx4 v[136:139], v241, s[12:15], s28 offen offset:3072 sc1
buffer_store_dwordx4 v[140:143], v241, s[12:15], s29 offen offset:0 sc1
L_nowo2_3:
v_add_u32 v200, 0, v241
v_add_u32 v201, 40960, v241
v_add_u32 v202, 81920, v241
v_mul_u32_u24 v2, 384, v252
v_min_u32 v3, 23, v251
v_lshlrev_b32 v3, 4, v3
v_add_u32 v2, v2, v3
v_add_u32 v203, 122880, v2
v_add_u32 v204, 51200, v241
v_add_u32 v205, 112640, v241
s_cmp_eq_u32 s22, 0
s_cselect_b64 s[32:33], -1, 0
v_mov_b32 v7, 0x7fff0000
v_cndmask_b32 v212, v7, v236, s[32:33]
s_cmp_eq_u32 s22, 1
s_cselect_b64 s[32:33], -1, 0
v_mov_b32 v7, 0x7fff0000
v_cndmask_b32 v213, v7, v236, s[32:33]
s_cmp_eq_u32 s22, 2
s_cselect_b64 s[32:33], -1, 0
v_mov_b32 v7, 0x7fff0000
v_cndmask_b32 v214, v7, v236, s[32:33]
s_cmp_eq_u32 s22, 3
s_cselect_b64 s[32:33], -1, 0
v_mov_b32 v7, 0x7fff0000
v_cndmask_b32 v215, v7, v236, s[32:33]
s_lshl_b32 s28, s22, 9
s_add_u32 s28, s28, 4096
v_lshlrev_b32 v2, 4, v251
v_add_u32 v6, s28, v2
v_mul_u32_u24 v3, 6144, v252
v_add_u32 v206, v3, v6
v_mul_u32_u24 v4, 6208, v252
v_add_u32 v4, v4, v6
v_add_u32 v207, 36864, v4
v_mul_u32_u24 v5, 18624, v252
v_add_u32 v5, v5, v6
v_add_u32 v208, 49280, v5
v_lshlrev_b32 v7, 11, v252
v_add_u32 v209, v7, v2
v_mul_u32_u24 v8, 6144, v252
v_add_u32 v8, v8, v2
v_add_u32 v210, 4096, v8
s_waitcnt vmcnt(0)
s_barrier
s_cmp_eq_u32 s22, 0
s_cbranch_scc1 L_f0w0_6
v_lshlrev_b32 v1, 2, v252
v_sub_u32 v1, v251, v1
v_mov_b32 v2, 0xf149f2ca
v_add_u32 v3, 0, v1
v_and_b32 v3, 0xfffffff1, v3
v_subrev_u32 v4, 1, v1
v_and_b32 v4, 0xfffffff1, v4
v_subrev_u32 v5, 2, v1
v_and_b32 v5, 0xfffffff1, v5
v_subrev_u32 v6, 3, v1
v_and_b32 v6, 0xfffffff1, v6
v_cmp_eq_u32 s[32:33], 0, v3
v_cmp_eq_u32 s[34:35], 0, v4
v_cmp_eq_u32 s[36:37], 0, v5
v_cmp_eq_u32 s[38:39], 0, v6
v_cndmask_b32 v144, v2, 0, s[32:33]
v_cndmask_b32 v145, v2, 0, s[34:35]
v_cndmask_b32 v146, v2, 0, s[36:37]
v_cndmask_b32 v147, v2, 0, s[38:39]
v_subrev_u32 v3, 8, v1
v_and_b32 v3, 0xfffffff1, v3
v_subrev_u32 v4, 9, v1
v_and_b32 v4, 0xfffffff1, v4
v_subrev_u32 v5, 10, v1
v_and_b32 v5, 0xfffffff1, v5
v_subrev_u32 v6, 11, v1
v_and_b32 v6, 0xfffffff1, v6
v_cmp_eq_u32 s[32:33], 0, v3
v_cmp_eq_u32 s[34:35], 0, v4
v_cmp_eq_u32 s[36:37], 0, v5
v_cmp_eq_u32 s[38:39], 0, v6
v_cndmask_b32 v148, v2, 0, s[32:33]
v_cndmask_b32 v149, v2, 0, s[34:35]
v_cndmask_b32 v150, v2, 0, s[36:37]
v_cndmask_b32 v151, v2, 0, s[38:39]
v_subrev_u32 v3, 16, v1
v_and_b32 v3, 0xfffffff1, v3
v_subrev_u32 v4, 17, v1
v_and_b32 v4, 0xfffffff1, v4
v_subrev_u32 v5, 18, v1
v_and_b32 v5, 0xfffffff1, v5
v_subrev_u32 v6, 19, v1
v_and_b32 v6, 0xfffffff1, v6
v_cmp_eq_u32 s[32:33], 0, v3
v_cmp_eq_u32 s[34:35], 0, v4
v_cmp_eq_u32 s[36:37], 0, v5
v_cmp_eq_u32 s[38:39], 0, v6
v_cndmask_b32 v152, v2, 0, s[32:33]
v_cndmask_b32 v153, v2, 0, s[34:35]
v_cndmask_b32 v154, v2, 0, s[36:37]
v_cndmask_b32 v155, v2, 0, s[38:39]
v_subrev_u32 v3, 24, v1
v_and_b32 v3, 0xfffffff1, v3
v_subrev_u32 v4, 25, v1
v_and_b32 v4, 0xfffffff1, v4
v_subrev_u32 v5, 26, v1
v_and_b32 v5, 0xfffffff1, v5
v_subrev_u32 v6, 27, v1
v_and_b32 v6, 0xfffffff1, v6
v_cmp_eq_u32 s[32:33], 0, v3
v_cmp_eq_u32 s[34:35], 0, v4
v_cmp_eq_u32 s[36:37], 0, v5
v_cmp_eq_u32 s[38:39], 0, v6
v_cndmask_b32 v156, v2, 0, s[32:33]
v_cndmask_b32 v157, v2, 0, s[34:35]
v_cndmask_b32 v158, v2, 0, s[36:37]
v_cndmask_b32 v159, v2, 0, s[38:39]
v_add_u32 v3, 32, v1
v_and_b32 v3, 0xfffffff1, v3
v_add_u32 v4, 31, v1
v_and_b32 v4, 0xfffffff1, v4
v_add_u32 v5, 30, v1
v_and_b32 v5, 0xfffffff1, v5
v_add_u32 v6, 29, v1
v_and_b32 v6, 0xfffffff1, v6
v_cmp_eq_u32 s[32:33], 0, v3
v_cmp_eq_u32 s[34:35], 0, v4
v_cmp_eq_u32 s[36:37], 0, v5
v_cmp_eq_u32 s[38:39], 0, v6
v_cndmask_b32 v160, v2, 0, s[32:33]
v_cndmask_b32 v161, v2, 0, s[34:35]
v_cndmask_b32 v162, v2, 0, s[36:37]
v_cndmask_b32 v163, v2, 0, s[38:39]
v_add_u32 v3, 24, v1
v_and_b32 v3, 0xfffffff1, v3
v_add_u32 v4, 23, v1
v_and_b32 v4, 0xfffffff1, v4
v_add_u32 v5, 22, v1
v_and_b32 v5, 0xfffffff1, v5
v_add_u32 v6, 21, v1
v_and_b32 v6, 0xfffffff1, v6
v_cmp_eq_u32 s[32:33], 0, v3
v_cmp_eq_u32 s[34:35], 0, v4
v_cmp_eq_u32 s[36:37], 0, v5
v_cmp_eq_u32 s[38:39], 0, v6
v_cndmask_b32 v164, v2, 0, s[32:33]
v_cndmask_b32 v165, v2, 0, s[34:35]
v_cndmask_b32 v166, v2, 0, s[36:37]
v_cndmask_b32 v167, v2, 0, s[38:39]
v_add_u32 v3, 16, v1
v_and_b32 v3, 0xfffffff1, v3
v_add_u32 v4, 15, v1
v_and_b32 v4, 0xfffffff1, v4
v_add_u32 v5, 14, v1
v_and_b32 v5, 0xfffffff1, v5
v_add_u32 v6, 13, v1
v_and_b32 v6, 0xfffffff1, v6
v_cmp_eq_u32 s[32:33], 0, v3
v_cmp_eq_u32 s[34:35], 0, v4
v_cmp_eq_u32 s[36:37], 0, v5
v_cmp_eq_u32 s[38:39], 0, v6
v_cndmask_b32 v168, v2, 0, s[32:33]
v_cndmask_b32 v169, v2, 0, s[34:35]
v_cndmask_b32 v170, v2, 0, s[36:37]
v_cndmask_b32 v171, v2, 0, s[38:39]
v_add_u32 v3, 8, v1
v_and_b32 v3, 0xfffffff1, v3
v_add_u32 v4, 7, v1
v_and_b32 v4, 0xfffffff1, v4
v_add_u32 v5, 6, v1
v_and_b32 v5, 0xfffffff1, v5
v_add_u32 v6, 5, v1
v_and_b32 v6, 0xfffffff1, v6
v_cmp_eq_u32 s[32:33], 0, v3
v_cmp_eq_u32 s[34:35], 0, v4
v_cmp_eq_u32 s[36:37], 0, v5
v_cmp_eq_u32 s[38:39], 0, v6
v_cndmask_b32 v172, v2, 0, s[32:33]
v_cndmask_b32 v173, v2, 0, s[34:35]
v_cndmask_b32 v174, v2, 0, s[36:37]
v_cndmask_b32 v175, v2, 0, s[38:39]
v_accvgpr_write_b32 a160, v144
v_accvgpr_write_b32 a161, v145
v_accvgpr_write_b32 a162, v146
v_accvgpr_write_b32 a163, v147
v_accvgpr_write_b32 a164, v148
v_accvgpr_write_b32 a165, v149
v_accvgpr_write_b32 a166, v150
v_accvgpr_write_b32 a167, v151
v_accvgpr_write_b32 a168, v152
v_accvgpr_write_b32 a169, v153
v_accvgpr_write_b32 a170, v154
v_accvgpr_write_b32 a171, v155
v_accvgpr_write_b32 a172, v156
v_accvgpr_write_b32 a173, v157
v_accvgpr_write_b32 a174, v158
v_accvgpr_write_b32 a175, v159
v_accvgpr_write_b32 a176, v160
v_accvgpr_write_b32 a177, v161
v_accvgpr_write_b32 a178, v162
v_accvgpr_write_b32 a179, v163
v_accvgpr_write_b32 a180, v164
v_accvgpr_write_b32 a181, v165
v_accvgpr_write_b32 a182, v166
v_accvgpr_write_b32 a183, v167
v_accvgpr_write_b32 a184, v168
v_accvgpr_write_b32 a185, v169
v_accvgpr_write_b32 a186, v170
v_accvgpr_write_b32 a187, v171
v_accvgpr_write_b32 a188, v172
v_accvgpr_write_b32 a189, v173
v_accvgpr_write_b32 a190, v174
v_accvgpr_write_b32 a191, v175
v_lshlrev_b32 v1, 2, v252
v_sub_u32 v1, v251, v1
v_mov_b32 v2, 0xf149f2ca
v_cmp_le_i32 s[32:33], 0, v1
v_cmp_le_i32 s[34:35], 1, v1
v_cmp_le_i32 s[36:37], 2, v1
v_cmp_le_i32 s[38:39], 3, v1
v_cndmask_b32 v144, v2, 0, s[32:33]
v_cndmask_b32 v160, 0, v2, s[32:33]
v_cndmask_b32 v145, v2, 0, s[34:35]
v_cndmask_b32 v161, 0, v2, s[34:35]
v_cndmask_b32 v146, v2, 0, s[36:37]
v_cndmask_b32 v162, 0, v2, s[36:37]
v_cndmask_b32 v147, v2, 0, s[38:39]
v_cndmask_b32 v163, 0, v2, s[38:39]
v_cmp_le_i32 s[32:33], 8, v1
v_cmp_le_i32 s[34:35], 9, v1
v_cmp_le_i32 s[36:37], 10, v1
v_cmp_le_i32 s[38:39], 11, v1
v_cndmask_b32 v148, v2, 0, s[32:33]
v_cndmask_b32 v164, 0, v2, s[32:33]
v_cndmask_b32 v149, v2, 0, s[34:35]
v_cndmask_b32 v165, 0, v2, s[34:35]
v_cndmask_b32 v150, v2, 0, s[36:37]
v_cndmask_b32 v166, 0, v2, s[36:37]
v_cndmask_b32 v151, v2, 0, s[38:39]
v_cndmask_b32 v167, 0, v2, s[38:39]
v_cmp_le_i32 s[32:33], 16, v1
v_cmp_le_i32 s[34:35], 17, v1
v_cmp_le_i32 s[36:37], 18, v1
v_cmp_le_i32 s[38:39], 19, v1
v_cndmask_b32 v152, v2, 0, s[32:33]
v_cndmask_b32 v168, 0, v2, s[32:33]
v_cndmask_b32 v153, v2, 0, s[34:35]
v_cndmask_b32 v169, 0, v2, s[34:35]
v_cndmask_b32 v154, v2, 0, s[36:37]
v_cndmask_b32 v170, 0, v2, s[36:37]
v_cndmask_b32 v155, v2, 0, s[38:39]
v_cndmask_b32 v171, 0, v2, s[38:39]
v_cmp_le_i32 s[32:33], 24, v1
v_cmp_le_i32 s[34:35], 25, v1
v_cmp_le_i32 s[36:37], 26, v1
v_cmp_le_i32 s[38:39], 27, v1
v_cndmask_b32 v156, v2, 0, s[32:33]
v_cndmask_b32 v172, 0, v2, s[32:33]
v_cndmask_b32 v157, v2, 0, s[34:35]
v_cndmask_b32 v173, 0, v2, s[34:35]
v_cndmask_b32 v158, v2, 0, s[36:37]
v_cndmask_b32 v174, 0, v2, s[36:37]
v_cndmask_b32 v159, v2, 0, s[38:39]
v_cndmask_b32 v175, 0, v2, s[38:39]
v_accvgpr_write_b32 a192, v144
v_accvgpr_write_b32 a193, v145
v_accvgpr_write_b32 a194, v146
v_accvgpr_write_b32 a195, v147
v_accvgpr_write_b32 a196, v148
v_accvgpr_write_b32 a197, v149
v_accvgpr_write_b32 a198, v150
v_accvgpr_write_b32 a199, v151
v_accvgpr_write_b32 a200, v152
v_accvgpr_write_b32 a201, v153
v_accvgpr_write_b32 a202, v154
v_accvgpr_write_b32 a203, v155
v_accvgpr_write_b32 a204, v156
v_accvgpr_write_b32 a205, v157
v_accvgpr_write_b32 a206, v158
v_accvgpr_write_b32 a207, v159
v_accvgpr_write_b32 a208, v160
v_accvgpr_write_b32 a209, v161
v_accvgpr_write_b32 a210, v162
v_accvgpr_write_b32 a211, v163
v_accvgpr_write_b32 a212, v164
v_accvgpr_write_b32 a213, v165
v_accvgpr_write_b32 a214, v166
v_accvgpr_write_b32 a215, v167
v_accvgpr_write_b32 a216, v168
v_accvgpr_write_b32 a217, v169
v_accvgpr_write_b32 a218, v170
v_accvgpr_write_b32 a219, v171
v_accvgpr_write_b32 a220, v172
v_accvgpr_write_b32 a221, v173
v_accvgpr_write_b32 a222, v174
v_accvgpr_write_b32 a223, v175
s_lshl_b32 s28, s22, 9
v_lshlrev_b32 v2, 4, v251
v_add_u32 v2, s28, v2
v_mul_u32_u24 v3, 6144, v252
v_add_u32 v3, v3, v2
v_add_u32 v4, 24576, v2
v_and_b32 v5, 1, v254
v_lshrrev_b32 v6, 1, v0
v_and_b32 v6, 1, v6
v_cmp_eq_u32 vcc, 1, v5
v_mov_b32 v7, 2
s_nop 0
v_cndmask_b32 v6, v6, v7, vcc
v_mul_u32_u24 v6, 6208, v6
v_lshlrev_b32 v7, 2, v252
v_lshrrev_b32 v8, 2, v253
v_add_u32 v7, v7, v8
v_lshlrev_b32 v7, 4, v7
v_and_b32 v8, 1, v0
v_lshlrev_b32 v8, 3, v8
v_add_u32 v6, v6, v7
v_add_u32 v6, v6, v8
s_add_u32 s28, s28, 36864
v_add_u32 v5, s28, v6
v_lshrrev_b32 v6, 4, v251
v_mul_u32_u24 v6, 20480, v6
v_lshlrev_b32 v7, 4, v253
v_add_u32 v6, v6, v7
v_lshlrev_b32 v7, 8, v252
v_add_u32 v9, v6, v7
v_mov_b32 v10, v6
v_lshrrev_b32 v15, 3, v0
v_mul_u32_u24 v15, 20480, v15
v_and_b32 v13, 7, v0
s_cmp_eq_u32 s22, 3
s_cselect_b32 s28, 8, 0
v_add_u32 v13, s28, v13
v_min_u32 v13, 9, v13
v_lshlrev_b32 v13, 7, v13
v_add_u32 v15, v15, v13
s_cmp_ge_u32 s22, 2
s_cselect_b64 s[32:33], -1, 0
v_mov_b32 v13, 0x7fff0000
v_cndmask_b32 v15, v13, v15, s[32:33]
s_lshl_b32 s28, s20, 3
s_mul_i32 s28, s28, 20480
s_mul_i32 s29, s21, 1280
s_add_u32 s28, s28, s29
s_add_u32 s90, s28, 11534336
v_mov_b32 v196, v3
v_mov_b32 v197, v4
v_mov_b32 v198, v5
v_mov_b32 v199, v9
v_mov_b32 v211, v10
v_mov_b32 v224, v15
s_branch L_f0skip_4
L_f0w0_6:
s_add_u32 s24, s26, 1
s_addc_u32 s25, s27, 0
s_lshl_b32 s28, s20, 8
s_add_u32 s28, s28, 16384
s_lshl_b32 s29, s21, 4
s_add_u32 s29, s29, s28
s_getreg_b32 s30, hwreg(HW_REG_XCC_ID)
s_and_b32 s30, s30, 15
s_mov_b64 s[62:63], exec
s_mov_b64 exec, 1
v_mov_b32 v6, s29
v_mov_b32 v8, s24
v_mov_b32 v9, s25
v_mov_b32 v10, s30
v_mov_b32 v11, 0
buffer_store_dwordx4 v[8:11], v6, s[12:15], 0 offen sc1
s_lshl_b32 s31, s21, 7
s_add_u32 s31, s31, 65536
s_lshl_b32 s32, s20, 3
s_add_u32 s32, s32, s31
v_mov_b32 v7, s32
buffer_store_dwordx2 v[8:9], v7, s[12:15], 0 offen sc1
s_mov_b64 exec, s[62:63]
s_mov_b32 s92, s28
s_mov_b32 s93, s30
v_lshlrev_b32 v1, 2, v252
v_sub_u32 v1, v251, v1
v_mov_b32 v2, 0xf149f2ca
v_add_u32 v3, 0, v1
v_and_b32 v3, 0xfffffff1, v3
v_subrev_u32 v4, 1, v1
v_and_b32 v4, 0xfffffff1, v4
v_subrev_u32 v5, 2, v1
v_and_b32 v5, 0xfffffff1, v5
v_subrev_u32 v6, 3, v1
v_and_b32 v6, 0xfffffff1, v6
v_cmp_eq_u32 s[32:33], 0, v3
v_cmp_eq_u32 s[34:35], 0, v4
v_cmp_eq_u32 s[36:37], 0, v5
v_cmp_eq_u32 s[38:39], 0, v6
v_cndmask_b32 v144, v2, 0, s[32:33]
v_cndmask_b32 v145, v2, 0, s[34:35]
v_cndmask_b32 v146, v2, 0, s[36:37]
v_cndmask_b32 v147, v2, 0, s[38:39]
v_subrev_u32 v3, 8, v1
v_and_b32 v3, 0xfffffff1, v3
v_subrev_u32 v4, 9, v1
v_and_b32 v4, 0xfffffff1, v4
v_subrev_u32 v5, 10, v1
v_and_b32 v5, 0xfffffff1, v5
v_subrev_u32 v6, 11, v1
v_and_b32 v6, 0xfffffff1, v6
v_cmp_eq_u32 s[32:33], 0, v3
v_cmp_eq_u32 s[34:35], 0, v4
v_cmp_eq_u32 s[36:37], 0, v5
v_cmp_eq_u32 s[38:39], 0, v6
v_cndmask_b32 v148, v2, 0, s[32:33]
v_cndmask_b32 v149, v2, 0, s[34:35]
v_cndmask_b32 v150, v2, 0, s[36:37]
v_cndmask_b32 v151, v2, 0, s[38:39]
v_subrev_u32 v3, 16, v1
v_and_b32 v3, 0xfffffff1, v3
v_subrev_u32 v4, 17, v1
v_and_b32 v4, 0xfffffff1, v4
v_subrev_u32 v5, 18, v1
v_and_b32 v5, 0xfffffff1, v5
v_subrev_u32 v6, 19, v1
v_and_b32 v6, 0xfffffff1, v6
v_cmp_eq_u32 s[32:33], 0, v3
v_cmp_eq_u32 s[34:35], 0, v4
v_cmp_eq_u32 s[36:37], 0, v5
v_cmp_eq_u32 s[38:39], 0, v6
v_cndmask_b32 v152, v2, 0, s[32:33]
v_cndmask_b32 v153, v2, 0, s[34:35]
v_cndmask_b32 v154, v2, 0, s[36:37]
v_cndmask_b32 v155, v2, 0, s[38:39]
v_subrev_u32 v3, 24, v1
v_and_b32 v3, 0xfffffff1, v3
v_subrev_u32 v4, 25, v1
v_and_b32 v4, 0xfffffff1, v4
v_subrev_u32 v5, 26, v1
v_and_b32 v5, 0xfffffff1, v5
v_subrev_u32 v6, 27, v1
v_and_b32 v6, 0xfffffff1, v6
v_cmp_eq_u32 s[32:33], 0, v3
v_cmp_eq_u32 s[34:35], 0, v4
v_cmp_eq_u32 s[36:37], 0, v5
v_cmp_eq_u32 s[38:39], 0, v6
v_cndmask_b32 v156, v2, 0, s[32:33]
v_cndmask_b32 v157, v2, 0, s[34:35]
v_cndmask_b32 v158, v2, 0, s[36:37]
v_cndmask_b32 v159, v2, 0, s[38:39]
v_add_u32 v3, 32, v1
v_and_b32 v3, 0xfffffff1, v3
v_add_u32 v4, 31, v1
v_and_b32 v4, 0xfffffff1, v4
v_add_u32 v5, 30, v1
v_and_b32 v5, 0xfffffff1, v5
v_add_u32 v6, 29, v1
v_and_b32 v6, 0xfffffff1, v6
v_cmp_eq_u32 s[32:33], 0, v3
v_cmp_eq_u32 s[34:35], 0, v4
v_cmp_eq_u32 s[36:37], 0, v5
v_cmp_eq_u32 s[38:39], 0, v6
v_cndmask_b32 v160, v2, 0, s[32:33]
v_cndmask_b32 v161, v2, 0, s[34:35]
v_cndmask_b32 v162, v2, 0, s[36:37]
v_cndmask_b32 v163, v2, 0, s[38:39]
v_add_u32 v3, 24, v1
v_and_b32 v3, 0xfffffff1, v3
v_add_u32 v4, 23, v1
v_and_b32 v4, 0xfffffff1, v4
v_add_u32 v5, 22, v1
v_and_b32 v5, 0xfffffff1, v5
v_add_u32 v6, 21, v1
v_and_b32 v6, 0xfffffff1, v6
v_cmp_eq_u32 s[32:33], 0, v3
v_cmp_eq_u32 s[34:35], 0, v4
v_cmp_eq_u32 s[36:37], 0, v5
v_cmp_eq_u32 s[38:39], 0, v6
v_cndmask_b32 v164, v2, 0, s[32:33]
v_cndmask_b32 v165, v2, 0, s[34:35]
v_cndmask_b32 v166, v2, 0, s[36:37]
v_cndmask_b32 v167, v2, 0, s[38:39]
v_add_u32 v3, 16, v1
v_and_b32 v3, 0xfffffff1, v3
v_add_u32 v4, 15, v1
v_and_b32 v4, 0xfffffff1, v4
v_add_u32 v5, 14, v1
v_and_b32 v5, 0xfffffff1, v5
v_add_u32 v6, 13, v1
v_and_b32 v6, 0xfffffff1, v6
v_cmp_eq_u32 s[32:33], 0, v3
v_cmp_eq_u32 s[34:35], 0, v4
v_cmp_eq_u32 s[36:37], 0, v5
v_cmp_eq_u32 s[38:39], 0, v6
v_cndmask_b32 v168, v2, 0, s[32:33]
v_cndmask_b32 v169, v2, 0, s[34:35]
v_cndmask_b32 v170, v2, 0, s[36:37]
v_cndmask_b32 v171, v2, 0, s[38:39]
v_add_u32 v3, 8, v1
v_and_b32 v3, 0xfffffff1, v3
v_add_u32 v4, 7, v1
v_and_b32 v4, 0xfffffff1, v4
v_add_u32 v5, 6, v1
v_and_b32 v5, 0xfffffff1, v5
v_add_u32 v6, 5, v1
v_and_b32 v6, 0xfffffff1, v6
v_cmp_eq_u32 s[32:33], 0, v3
v_cmp_eq_u32 s[34:35], 0, v4
v_cmp_eq_u32 s[36:37], 0, v5
v_cmp_eq_u32 s[38:39], 0, v6
v_cndmask_b32 v172, v2, 0, s[32:33]
v_cndmask_b32 v173, v2, 0, s[34:35]
v_cndmask_b32 v174, v2, 0, s[36:37]
v_cndmask_b32 v175, v2, 0, s[38:39]
v_accvgpr_write_b32 a160, v144
v_accvgpr_write_b32 a161, v145
v_accvgpr_write_b32 a162, v146
v_accvgpr_write_b32 a163, v147
v_accvgpr_write_b32 a164, v148
v_accvgpr_write_b32 a165, v149
v_accvgpr_write_b32 a166, v150
v_accvgpr_write_b32 a167, v151
v_accvgpr_write_b32 a168, v152
v_accvgpr_write_b32 a169, v153
v_accvgpr_write_b32 a170, v154
v_accvgpr_write_b32 a171, v155
v_accvgpr_write_b32 a172, v156
v_accvgpr_write_b32 a173, v157
v_accvgpr_write_b32 a174, v158
v_accvgpr_write_b32 a175, v159
v_accvgpr_write_b32 a176, v160
v_accvgpr_write_b32 a177, v161
v_accvgpr_write_b32 a178, v162
v_accvgpr_write_b32 a179, v163
v_accvgpr_write_b32 a180, v164
v_accvgpr_write_b32 a181, v165
v_accvgpr_write_b32 a182, v166
v_accvgpr_write_b32 a183, v167
v_accvgpr_write_b32 a184, v168
v_accvgpr_write_b32 a185, v169
v_accvgpr_write_b32 a186, v170
v_accvgpr_write_b32 a187, v171
v_accvgpr_write_b32 a188, v172
v_accvgpr_write_b32 a189, v173
v_accvgpr_write_b32 a190, v174
v_accvgpr_write_b32 a191, v175
v_lshlrev_b32 v1, 2, v252
v_sub_u32 v1, v251, v1
v_mov_b32 v2, 0xf149f2ca
v_cmp_le_i32 s[32:33], 0, v1
v_cmp_le_i32 s[34:35], 1, v1
v_cmp_le_i32 s[36:37], 2, v1
v_cmp_le_i32 s[38:39], 3, v1
v_cndmask_b32 v144, v2, 0, s[32:33]
v_cndmask_b32 v160, 0, v2, s[32:33]
v_cndmask_b32 v145, v2, 0, s[34:35]
v_cndmask_b32 v161, 0, v2, s[34:35]
v_cndmask_b32 v146, v2, 0, s[36:37]
v_cndmask_b32 v162, 0, v2, s[36:37]
v_cndmask_b32 v147, v2, 0, s[38:39]
v_cndmask_b32 v163, 0, v2, s[38:39]
v_cmp_le_i32 s[32:33], 8, v1
v_cmp_le_i32 s[34:35], 9, v1
v_cmp_le_i32 s[36:37], 10, v1
v_cmp_le_i32 s[38:39], 11, v1
v_cndmask_b32 v148, v2, 0, s[32:33]
v_cndmask_b32 v164, 0, v2, s[32:33]
v_cndmask_b32 v149, v2, 0, s[34:35]
v_cndmask_b32 v165, 0, v2, s[34:35]
v_cndmask_b32 v150, v2, 0, s[36:37]
v_cndmask_b32 v166, 0, v2, s[36:37]
v_cndmask_b32 v151, v2, 0, s[38:39]
v_cndmask_b32 v167, 0, v2, s[38:39]
v_cmp_le_i32 s[32:33], 16, v1
v_cmp_le_i32 s[34:35], 17, v1
v_cmp_le_i32 s[36:37], 18, v1
v_cmp_le_i32 s[38:39], 19, v1
v_cndmask_b32 v152, v2, 0, s[32:33]
v_cndmask_b32 v168, 0, v2, s[32:33]
v_cndmask_b32 v153, v2, 0, s[34:35]
v_cndmask_b32 v169, 0, v2, s[34:35]
v_cndmask_b32 v154, v2, 0, s[36:37]
v_cndmask_b32 v170, 0, v2, s[36:37]
v_cndmask_b32 v155, v2, 0, s[38:39]
v_cndmask_b32 v171, 0, v2, s[38:39]
v_cmp_le_i32 s[32:33], 24, v1
v_cmp_le_i32 s[34:35], 25, v1
v_cmp_le_i32 s[36:37], 26, v1
v_cmp_le_i32 s[38:39], 27, v1
v_cndmask_b32 v156, v2, 0, s[32:33]
v_cndmask_b32 v172, 0, v2, s[32:33]
v_cndmask_b32 v157, v2, 0, s[34:35]
v_cndmask_b32 v173, 0, v2, s[34:35]
v_cndmask_b32 v158, v2, 0, s[36:37]
v_cndmask_b32 v174, 0, v2, s[36:37]
v_cndmask_b32 v159, v2, 0, s[38:39]
v_cndmask_b32 v175, 0, v2, s[38:39]
v_accvgpr_write_b32 a192, v144
v_accvgpr_write_b32 a193, v145
v_accvgpr_write_b32 a194, v146
v_accvgpr_write_b32 a195, v147
v_accvgpr_write_b32 a196, v148
v_accvgpr_write_b32 a197, v149
v_accvgpr_write_b32 a198, v150
v_accvgpr_write_b32 a199, v151
v_accvgpr_write_b32 a200, v152
v_accvgpr_write_b32 a201, v153
v_accvgpr_write_b32 a202, v154
v_accvgpr_write_b32 a203, v155
v_accvgpr_write_b32 a204, v156
v_accvgpr_write_b32 a205, v157
v_accvgpr_write_b32 a206, v158
v_accvgpr_write_b32 a207, v159
v_accvgpr_write_b32 a208, v160
v_accvgpr_write_b32 a209, v161
v_accvgpr_write_b32 a210, v162
v_accvgpr_write_b32 a211, v163
v_accvgpr_write_b32 a212, v164
v_accvgpr_write_b32 a213, v165
v_accvgpr_write_b32 a214, v166
v_accvgpr_write_b32 a215, v167
v_accvgpr_write_b32 a216, v168
v_accvgpr_write_b32 a217, v169
v_accvgpr_write_b32 a218, v170
v_accvgpr_write_b32 a219, v171
v_accvgpr_write_b32 a220, v172
v_accvgpr_write_b32 a221, v173
v_accvgpr_write_b32 a222, v174
v_accvgpr_write_b32 a223, v175
s_lshl_b32 s28, s22, 9
v_lshlrev_b32 v2, 4, v251
v_add_u32 v2, s28, v2
v_mul_u32_u24 v3, 6144, v252
v_add_u32 v3, v3, v2
v_add_u32 v4, 24576, v2
v_and_b32 v5, 1, v254
v_lshrrev_b32 v6, 1, v0
v_and_b32 v6, 1, v6
v_cmp_eq_u32 vcc, 1, v5
v_mov_b32 v7, 2
s_nop 0
v_cndmask_b32 v6, v6, v7, vcc
v_mul_u32_u24 v6, 6208, v6
v_lshlrev_b32 v7, 2, v252
v_lshrrev_b32 v8, 2, v253
v_add_u32 v7, v7, v8
v_lshlrev_b32 v7, 4, v7
v_and_b32 v8, 1, v0
v_lshlrev_b32 v8, 3, v8
v_add_u32 v6, v6, v7
v_add_u32 v6, v6, v8
s_add_u32 s28, s28, 36864
v_add_u32 v5, s28, v6
v_lshrrev_b32 v6, 4, v251
v_mul_u32_u24 v6, 20480, v6
v_lshlrev_b32 v7, 4, v253
v_add_u32 v6, v6, v7
v_lshlrev_b32 v7, 8, v252
v_add_u32 v9, v6, v7
v_mov_b32 v10, v6
v_lshrrev_b32 v15, 3, v0
v_mul_u32_u24 v15, 20480, v15
v_and_b32 v13, 7, v0
s_cmp_eq_u32 s22, 3
s_cselect_b32 s28, 8, 0
v_add_u32 v13, s28, v13
v_min_u32 v13, 9, v13
v_lshlrev_b32 v13, 7, v13
v_add_u32 v15, v15, v13
s_cmp_ge_u32 s22, 2
s_cselect_b64 s[32:33], -1, 0
v_mov_b32 v13, 0x7fff0000
v_cndmask_b32 v15, v13, v15, s[32:33]
s_lshl_b32 s28, s20, 3
s_mul_i32 s28, s28, 20480
s_mul_i32 s29, s21, 1280
s_add_u32 s28, s28, s29
s_add_u32 s90, s28, 11534336
v_mov_b32 v196, v3
v_mov_b32 v197, v4
v_mov_b32 v198, v5
v_mov_b32 v199, v9
v_mov_b32 v211, v10
v_mov_b32 v224, v15
s_mov_b32 s28, s92
s_mov_b32 s30, s93
s_mov_b32 exec_lo, -1
s_mov_b32 exec_hi, 0xffff
s_and_b32 s31, s21, 14
s_lshl_b32 s31, s31, 7
s_add_u32 s31, s31, 65536
v_lshlrev_b32 v6, 4, v0
v_add_u32 v6, s28, v6
v_subrev_u32 v7, 16, v0
v_lshlrev_b32 v7, 3, v7
v_add_u32 v7, s31, v7
v_cmp_gt_u32 vcc, 16, v0
s_nop 1
v_cndmask_b32 v6, v7, v6, vcc
s_mov_b32 s39, 524288
L_poll_7:
buffer_load_dwordx4 v[8:11], v6, s[12:15], 0 offen sc1
s_waitcnt vmcnt(0)
v_cmp_ne_u64 vcc, s[24:25], v[8:9]
s_cmp_eq_u64 vcc, 0
s_cbranch_scc1 L_pdone_8
s_sub_u32 s39, s39, 1
s_cmp_lg_u32 s39, 0
s_cbranch_scc1 L_poll_7
L_pdone_8:
s_mov_b64 exec, 0xffff
v_cmp_ne_u64 vcc, s[24:25], v[8:9]
s_mov_b64 s[32:33], vcc
v_cmp_ne_u32 vcc, s30, v10
s_or_b64 s[32:33], s[32:33], vcc
s_cmp_eq_u64 s[32:33], 0
s_cselect_b32 s31, 1, 0
s_mov_b64 exec, 1
v_mov_b32 v6, 153600
v_mov_b32 v7, s31
ds_write_b32 v6, v7
s_waitcnt lgkmcnt(0)
s_mov_b64 exec, s[62:63]
L_f0skip_4:
s_barrier
v_mov_b32 v6, 153600
ds_read_b32 v7, v6
s_waitcnt lgkmcnt(0)
v_readfirstlane_b32 s60, v7
s_lshl_b32 s28, s22, 8
v_lshlrev_b32 v2, 2, v0
v_add_u32 v2, s28, v2
v_and_b32 v3, 0x1ff, v2
s_lshr_b32 s28, s22, 1
s_lshl_b32 s28, s28, 4
s_add_u32 s28, s28, s21
s_lshl_b32 s28, s28, 12
s_add_u32 s28, s28, 655360
buffer_load_dword v32, v3, s[12:15], s28 offen offset:0 sc1
buffer_load_dword v33, v3, s[12:15], s28 offen offset:512 sc1
buffer_load_dword v34, v3, s[12:15], s28 offen offset:1024 sc1
buffer_load_dword v35, v3, s[12:15], s28 offen offset:1536 sc1
buffer_load_dword v36, v3, s[12:15], s28 offen offset:2048 sc1
buffer_load_dword v37, v3, s[12:15], s28 offen offset:2560 sc1
buffer_load_dword v38, v3, s[12:15], s28 offen offset:3072 sc1
buffer_load_dword v39, v3, s[12:15], s28 offen offset:3584 sc1
s_and_b32 s28, s23, 1
s_mul_i32 s28, s28, 0x280000
s_mul_i32 s29, s21, 0x28000
s_add_u32 s28, s28, s29
s_add_u32 s28, s28, 52428800
s_add_u32 s4, s56, s28
s_addc_u32 s5, s57, 0
s_cmp_lt_u32 s23, 4
s_cselect_b32 s6, 153600, 0
s_mov_b32 s7, 0x20000
s_lshl_b32 s85, s22, 10
s_add_u32 s85, s85, 0
s_mov_b32 m0, s85
s_nop 0
buffer_load_dwordx4 v241, s[4:7], s85 offen lds
s_lshl_b32 s85, s22, 10
s_add_u32 s85, s85, 40960
s_mov_b32 m0, s85
s_nop 0
buffer_load_dwordx4 v241, s[4:7], s85 offen lds
s_lshl_b32 s85, s22, 10
s_add_u32 s85, s85, 81920
s_mov_b32 m0, s85
s_nop 0
buffer_load_dwordx4 v241, s[4:7], s85 offen lds
s_lshl_b32 s85, s22, 10
s_add_u32 s85, s85, 4096
s_mov_b32 m0, s85
s_nop 0
buffer_load_dwordx4 v241, s[4:7], s85 offen lds
s_lshl_b32 s85, s22, 10
s_add_u32 s85, s85, 45056
s_mov_b32 m0, s85
s_nop 0
buffer_load_dwordx4 v241, s[4:7], s85 offen lds
s_lshl_b32 s85, s22, 10
s_add_u32 s85, s85, 86016
s_mov_b32 m0, s85
s_nop 0
buffer_load_dwordx4 v241, s[4:7], s85 offen lds
s_waitcnt vmcnt(6)
v_add_f32 v32, v32, v33
v_add_f32 v32, v32, v34
v_add_f32 v32, v32, v35
v_add_f32 v32, v32, v36
v_add_f32 v32, v32, v37
v_add_f32 v32, v32, v38
v_add_f32 v32, v32, v39
v_add_u32 v2, 155648, v2
ds_write_b32 v2, v32
L_layer:
s_mul_i32 s76, s23, 0
s_add_u32 s76, s76, 1048576
s_lshl_b32 s28, s20, 2
s_add_u32 s28, s28, s22
s_mul_i32 s28, s28, 40960
s_add_u32 s76, s76, s28
s_mul_i32 s77, s23, 0
s_add_u32 s77, s77, 131072
s_lshl_b32 s28, s20, 1
s_lshr_b32 s29, s22, 1
s_add_u32 s28, s28, s29
s_lshl_b32 s28, s28, 12
s_add_u32 s77, s77, s28
s_and_b32 s29, s22, 1
s_lshl_b32 s29, s29, 8
s_add_u32 s77, s77, s29
v_lshlrev_b32 v1, 3, v251
v_lshlrev_b32 v2, 11, v252
v_add_u32 v1, v1, v2
s_cmp_lg_u32 s23, 0
s_cbranch_scc1 L_nostream_9
buffer_load_dwordx4 a[0:3], v241, s[12:15], s76 offen offset:0 sc1
buffer_load_dwordx4 a[4:7], v241, s[12:15], s76 offen offset:1024 sc1
buffer_load_dwordx4 a[8:11], v241, s[12:15], s76 offen offset:2048 sc1
buffer_load_dwordx4 a[12:15], v241, s[12:15], s76 offen offset:3072 sc1
s_add_u32 s76, s76, 4096
buffer_load_dwordx4 a[16:19], v241, s[12:15], s76 offen offset:0 sc1
buffer_load_dwordx4 a[20:23], v241, s[12:15], s76 offen offset:1024 sc1
buffer_load_dwordx4 a[24:27], v241, s[12:15], s76 offen offset:2048 sc1
buffer_load_dwordx4 a[28:31], v241, s[12:15], s76 offen offset:3072 sc1
s_and_b32 s28, s23, 1
s_lshl_b32 s28, s28, 3
s_add_u32 s28, s28, s59
s_mul_i32 s28, s28, 0x19000
s_add_u32 s28, s28, 58720256
s_add_u32 s8, s56, s28
s_addc_u32 s9, s57, 0
s_mov_b32 s10, 102400
s_mov_b32 s11, 0x20000
s_add_u32 s28, s23, 1
s_and_b32 s29, s28, 1
s_mul_i32 s29, s29, 0x280000
s_mul_i32 s30, s21, 0x28000
s_add_u32 s29, s29, s30
s_add_u32 s29, s29, 52428800
s_add_u32 s80, s56, s29
s_addc_u32 s81, s57, 0
s_cmp_lt_u32 s23, 3
s_cselect_b32 s82, 153600, 0
s_mov_b32 s83, 0x20000
s_and_b32 s28, s20, 1
s_lshl_b32 s89, s28, 13
s_and_b32 s28, s20, 1
s_lshl_b32 s28, s28, 1
s_add_u32 s28, s28, s58
s_mul_i32 s93, s28, 25600
s_lshl_b32 s86, s22, 10
s_waitcnt vmcnt(7)
s_waitcnt lgkmcnt(0)
s_barrier
ds_read_b128 v[128:131], v200 offset:0
ds_read_b128 v[132:135], v201 offset:0
ds_read_b128 v[136:139], v202 offset:0
ds_read_b128 v[140:143], v200 offset:1024
ds_read_b128 v[144:147], v201 offset:1024
ds_read_b128 v[148:151], v202 offset:1024
s_waitcnt vmcnt(7)
s_waitcnt lgkmcnt(3)
v_mfma_f32_32x32x16_bf16 v[64:79], v[128:131], a[0:3], 0
ds_read_b128 v[152:155], v200 offset:2048
s_add_u32 s76, s76, 4096
buffer_load_dwordx4 a[32:35], v241, s[12:15], s76 offen offset:0 sc1
v_mfma_f32_32x32x16_bf16 v[80:95], v[132:135], a[0:3], 0
ds_read_b128 v[156:159], v201 offset:2048
s_add_u32 s85, s86, 8192
s_mov_b32 m0, s85
s_nop 0
buffer_load_dwordx4 v241, s[4:7], s85 offen lds
v_mfma_f32_32x32x16_bf16 v[96:111], v[136:139], a[0:3], 0
ds_read_b128 v[160:163], v202 offset:2048
s_waitcnt vmcnt(8)
s_waitcnt lgkmcnt(3)
v_mfma_f32_32x32x16_bf16 v[64:79], v[140:143], a[4:7], v[64:79]
ds_read_b128 v[128:131], v200 offset:3072
buffer_load_dwordx4 a[36:39], v241, s[12:15], s76 offen offset:1024 sc1
v_mfma_f32_32x32x16_bf16 v[80:95], v[144:147], a[4:7], v[80:95]
ds_read_b128 v[132:135], v201 offset:3072
s_add_u32 s85, s86, 49152
s_mov_b32 m0, s85
s_nop 0
buffer_load_dwordx4 v241, s[4:7], s85 offen lds
v_mfma_f32_32x32x16_bf16 v[96:111], v[148:151], a[4:7], v[96:111]
ds_read_b128 v[136:139], v202 offset:3072
s_waitcnt vmcnt(9)
s_waitcnt lgkmcnt(3)
v_mfma_f32_32x32x16_bf16 v[64:79], v[152:155], a[8:11], v[64:79]
ds_read_b128 v[140:143], v200 offset:4096
buffer_load_dwordx4 a[40:43], v241, s[12:15], s76 offen offset:2048 sc1
v_mfma_f32_32x32x16_bf16 v[80:95], v[156:159], a[8:11], v[80:95]
ds_read_b128 v[144:147], v201 offset:4096
s_add_u32 s85, s86, 90112
s_mov_b32 m0, s85
s_nop 0
buffer_load_dwordx4 v241, s[4:7], s85 offen lds
v_mfma_f32_32x32x16_bf16 v[96:111], v[160:163], a[8:11], v[96:111]
ds_read_b128 v[148:151], v202 offset:4096
s_waitcnt vmcnt(10)
s_waitcnt lgkmcnt(3)
v_mfma_f32_32x32x16_bf16 v[64:79], v[128:131], a[12:15], v[64:79]
ds_read_b128 v[152:155], v200 offset:5120
buffer_load_dwordx4 a[44:47], v241, s[12:15], s76 offen offset:3072 sc1
v_mfma_f32_32x32x16_bf16 v[80:95], v[132:135], a[12:15], v[80:95]
ds_read_b128 v[156:159], v201 offset:5120
s_add_u32 s85, s86, 12288
s_mov_b32 m0, s85
s_nop 0
buffer_load_dwordx4 v241, s[4:7], s85 offen lds
v_mfma_f32_32x32x16_bf16 v[96:111], v[136:139], a[12:15], v[96:111]
ds_read_b128 v[160:163], v202 offset:5120
s_waitcnt vmcnt(11)
s_waitcnt lgkmcnt(3)
v_mfma_f32_32x32x16_bf16 v[64:79], v[140:143], a[16:19], v[64:79]
ds_read_b128 v[128:131], v200 offset:6144
s_add_u32 s76, s76, 4096
buffer_load_dwordx4 a[48:51], v241, s[12:15], s76 offen offset:0 sc1
v_mfma_f32_32x32x16_bf16 v[80:95], v[144:147], a[16:19], v[80:95]
ds_read_b128 v[132:135], v201 offset:6144
s_add_u32 s85, s86, 53248
s_mov_b32 m0, s85
s_nop 0
buffer_load_dwordx4 v241, s[4:7], s85 offen lds
v_mfma_f32_32x32x16_bf16 v[96:111], v[148:151], a[16:19], v[96:111]
ds_read_b128 v[136:139], v202 offset:6144
s_waitcnt vmcnt(12)
s_waitcnt lgkmcnt(3)
v_mfma_f32_32x32x16_bf16 v[64:79], v[152:155], a[20:23], v[64:79]
ds_read_b128 v[140:143], v200 offset:7168
buffer_load_dwordx4 a[52:55], v241, s[12:15], s76 offen offset:1024 sc1
v_mfma_f32_32x32x16_bf16 v[80:95], v[156:159], a[20:23], v[80:95]
ds_read_b128 v[144:147], v201 offset:7168
s_add_u32 s85, s86, 94208
s_mov_b32 m0, s85
s_nop 0
buffer_load_dwordx4 v241, s[4:7], s85 offen lds
v_mfma_f32_32x32x16_bf16 v[96:111], v[160:163], a[20:23], v[96:111]
ds_read_b128 v[148:151], v202 offset:7168
s_waitcnt vmcnt(13)
s_waitcnt vmcnt(6)
s_barrier
s_waitcnt lgkmcnt(3)
v_mfma_f32_32x32x16_bf16 v[64:79], v[128:131], a[24:27], v[64:79]
ds_read_b128 v[152:155], v200 offset:8192
buffer_load_dwordx4 a[56:59], v241, s[12:15], s76 offen offset:2048 sc1
v_mfma_f32_32x32x16_bf16 v[80:95], v[132:135], a[24:27], v[80:95]
ds_read_b128 v[156:159], v201 offset:8192
s_add_u32 s85, s86, 16384
s_mov_b32 m0, s85
s_nop 0
buffer_load_dwordx4 v241, s[4:7], s85 offen lds
v_mfma_f32_32x32x16_bf16 v[96:111], v[136:139], a[24:27], v[96:111]
ds_read_b128 v[160:163], v202 offset:8192
s_waitcnt vmcnt(14)
s_waitcnt lgkmcnt(3)
v_mfma_f32_32x32x16_bf16 v[64:79], v[140:143], a[28:31], v[64:79]
ds_read_b128 v[128:131], v200 offset:9216
buffer_load_dwordx4 a[60:63], v241, s[12:15], s76 offen offset:3072 sc1
v_mfma_f32_32x32x16_bf16 v[80:95], v[144:147], a[28:31], v[80:95]
ds_read_b128 v[132:135], v201 offset:9216
s_add_u32 s85, s86, 57344
s_mov_b32 m0, s85
s_nop 0
buffer_load_dwordx4 v241, s[4:7], s85 offen lds
v_mfma_f32_32x32x16_bf16 v[96:111], v[148:151], a[28:31], v[96:111]
ds_read_b128 v[136:139], v202 offset:9216
s_waitcnt vmcnt(15)
s_waitcnt lgkmcnt(3)
v_mfma_f32_32x32x16_bf16 v[64:79], v[152:155], a[32:35], v[64:79]
ds_read_b128 v[140:143], v200 offset:10240
s_add_u32 s76, s76, 4096
buffer_load_dwordx4 a[64:67], v241, s[12:15], s76 offen offset:0 sc1
v_mfma_f32_32x32x16_bf16 v[80:95], v[156:159], a[32:35], v[80:95]
ds_read_b128 v[144:147], v201 offset:10240
s_add_u32 s85, s86, 98304
s_mov_b32 m0, s85
s_nop 0
buffer_load_dwordx4 v241, s[4:7], s85 offen lds
v_mfma_f32_32x32x16_bf16 v[96:111], v[160:163], a[32:35], v[96:111]
ds_read_b128 v[148:151], v202 offset:10240
s_waitcnt vmcnt(15)
s_waitcnt lgkmcnt(3)
v_mfma_f32_32x32x16_bf16 v[64:79], v[128:131], a[36:39], v[64:79]
ds_read_b128 v[152:155], v200 offset:11264
buffer_load_dwordx4 a[68:71], v241, s[12:15], s76 offen offset:1024 sc1
v_mfma_f32_32x32x16_bf16 v[80:95], v[132:135], a[36:39], v[80:95]
ds_read_b128 v[156:159], v201 offset:11264
s_add_u32 s85, s86, 20480
s_mov_b32 m0, s85
s_nop 0
buffer_load_dwordx4 v241, s[4:7], s85 offen lds
v_mfma_f32_32x32x16_bf16 v[96:111], v[136:139], a[36:39], v[96:111]
ds_read_b128 v[160:163], v202 offset:11264
s_waitcnt vmcnt(15)
s_waitcnt vmcnt(8)
s_barrier
s_waitcnt lgkmcnt(3)
v_mfma_f32_32x32x16_bf16 v[64:79], v[140:143], a[40:43], v[64:79]
ds_read_b128 v[128:131], v200 offset:12288
buffer_load_dwordx4 a[72:75], v241, s[12:15], s76 offen offset:2048 sc1
v_mfma_f32_32x32x16_bf16 v[80:95], v[144:147], a[40:43], v[80:95]
ds_read_b128 v[132:135], v201 offset:12288
s_add_u32 s85, s86, 61440
s_mov_b32 m0, s85
s_nop 0
buffer_load_dwordx4 v241, s[4:7], s85 offen lds
v_mfma_f32_32x32x16_bf16 v[96:111], v[148:151], a[40:43], v[96:111]
ds_read_b128 v[136:139], v202 offset:12288
s_waitcnt vmcnt(15)
s_waitcnt lgkmcnt(3)
v_mfma_f32_32x32x16_bf16 v[64:79], v[152:155], a[44:47], v[64:79]
ds_read_b128 v[140:143], v200 offset:13312
buffer_load_dwordx4 a[76:79], v241, s[12:15], s76 offen offset:3072 sc1
v_mfma_f32_32x32x16_bf16 v[80:95], v[156:159], a[44:47], v[80:95]
ds_read_b128 v[144:147], v201 offset:13312
s_add_u32 s85, s86, 102400
s_mov_b32 m0, s85
s_nop 0
buffer_load_dwordx4 v241, s[4:7], s85 offen lds
v_mfma_f32_32x32x16_bf16 v[96:111], v[160:163], a[44:47], v[96:111]
ds_read_b128 v[148:151], v202 offset:13312
s_waitcnt vmcnt(15)
s_waitcnt lgkmcnt(3)
v_mfma_f32_32x32x16_bf16 v[64:79], v[128:131], a[48:51], v[64:79]
ds_read_b128 v[152:155], v200 offset:14336
s_add_u32 s76, s76, 4096
buffer_load_dwordx4 a[80:83], v241, s[12:15], s76 offen offset:0 sc1
v_mfma_f32_32x32x16_bf16 v[80:95], v[132:135], a[48:51], v[80:95]
ds_read_b128 v[156:159], v201 offset:14336
s_add_u32 s85, s86, 24576
s_mov_b32 m0, s85
s_nop 0
buffer_load_dwordx4 v241, s[4:7], s85 offen lds
v_mfma_f32_32x32x16_bf16 v[96:111], v[136:139], a[48:51], v[96:111]
ds_read_b128 v[160:163], v202 offset:14336
s_waitcnt vmcnt(15)
s_waitcnt lgkmcnt(3)
v_mfma_f32_32x32x16_bf16 v[64:79], v[140:143], a[52:55], v[64:79]
ds_read_b128 v[128:131], v200 offset:15360
buffer_load_dwordx4 a[84:87], v241, s[12:15], s76 offen offset:1024 sc1
v_mfma_f32_32x32x16_bf16 v[80:95], v[144:147], a[52:55], v[80:95]
ds_read_b128 v[132:135], v201 offset:15360
s_add_u32 s85, s86, 65536
s_mov_b32 m0, s85
s_nop 0
buffer_load_dwordx4 v241, s[4:7], s85 offen lds
v_mfma_f32_32x32x16_bf16 v[96:111], v[148:151], a[52:55], v[96:111]
ds_read_b128 v[136:139], v202 offset:15360
s_waitcnt vmcnt(15)
s_waitcnt vmcnt(10)
s_barrier
s_waitcnt lgkmcnt(3)
v_mfma_f32_32x32x16_bf16 v[64:79], v[152:155], a[56:59], v[64:79]
ds_read_b128 v[140:143], v200 offset:16384
buffer_load_dwordx4 a[88:91], v241, s[12:15], s76 offen offset:2048 sc1
v_mfma_f32_32x32x16_bf16 v[80:95], v[156:159], a[56:59], v[80:95]
ds_read_b128 v[144:147], v201 offset:16384
s_add_u32 s85, s86, 106496
s_mov_b32 m0, s85
s_nop 0
buffer_load_dwordx4 v241, s[4:7], s85 offen lds
v_mfma_f32_32x32x16_bf16 v[96:111], v[160:163], a[56:59], v[96:111]
ds_read_b128 v[148:151], v202 offset:16384
s_waitcnt vmcnt(15)
s_waitcnt lgkmcnt(3)
v_mfma_f32_32x32x16_bf16 v[64:79], v[128:131], a[60:63], v[64:79]
ds_read_b128 v[152:155], v200 offset:17408
buffer_load_dwordx4 a[92:95], v241, s[12:15], s76 offen offset:3072 sc1
v_mfma_f32_32x32x16_bf16 v[80:95], v[132:135], a[60:63], v[80:95]
ds_read_b128 v[156:159], v201 offset:17408
s_add_u32 s85, s86, 28672
s_mov_b32 m0, s85
s_nop 0
buffer_load_dwordx4 v241, s[4:7], s85 offen lds
v_mfma_f32_32x32x16_bf16 v[96:111], v[136:139], a[60:63], v[96:111]
ds_read_b128 v[160:163], v202 offset:17408
s_waitcnt vmcnt(15)
s_waitcnt lgkmcnt(3)
v_mfma_f32_32x32x16_bf16 v[64:79], v[140:143], a[64:67], v[64:79]
ds_read_b128 v[128:131], v200 offset:18432
s_add_u32 s76, s76, 4096
buffer_load_dwordx4 a[96:99], v241, s[12:15], s76 offen offset:0 sc1
v_mfma_f32_32x32x16_bf16 v[80:95], v[144:147], a[64:67], v[80:95]
ds_read_b128 v[132:135], v201 offset:18432
s_add_u32 s85, s86, 69632
s_mov_b32 m0, s85
s_nop 0
buffer_load_dwordx4 v241, s[4:7], s85 offen lds
v_mfma_f32_32x32x16_bf16 v[96:111], v[148:151], a[64:67], v[96:111]
ds_read_b128 v[136:139], v202 offset:18432
s_waitcnt vmcnt(15)
s_waitcnt lgkmcnt(3)
v_mfma_f32_32x32x16_bf16 v[64:79], v[152:155], a[68:71], v[64:79]
ds_read_b128 v[140:143], v200 offset:19456
buffer_load_dwordx4 a[100:103], v241, s[12:15], s76 offen offset:1024 sc1
v_mfma_f32_32x32x16_bf16 v[80:95], v[156:159], a[68:71], v[80:95]
ds_read_b128 v[144:147], v201 offset:19456
s_add_u32 s85, s86, 110592
s_mov_b32 m0, s85
s_nop 0
buffer_load_dwordx4 v241, s[4:7], s85 offen lds
v_mfma_f32_32x32x16_bf16 v[96:111], v[160:163], a[68:71], v[96:111]
ds_read_b128 v[148:151], v202 offset:19456
s_waitcnt vmcnt(15)
s_waitcnt vmcnt(12)
s_barrier
s_waitcnt lgkmcnt(3)
v_mfma_f32_32x32x16_bf16 v[64:79], v[128:131], a[72:75], v[64:79]
ds_read_b128 v[152:155], v200 offset:20480
buffer_load_dwordx4 a[104:107], v241, s[12:15], s76 offen offset:2048 sc1
v_mfma_f32_32x32x16_bf16 v[80:95], v[132:135], a[72:75], v[80:95]
ds_read_b128 v[156:159], v201 offset:20480
s_add_u32 s85, s86, 32768
s_mov_b32 m0, s85
s_nop 0
buffer_load_dwordx4 v241, s[4:7], s85 offen lds
v_mfma_f32_32x32x16_bf16 v[96:111], v[136:139], a[72:75], v[96:111]
ds_read_b128 v[160:163], v202 offset:20480
s_waitcnt vmcnt(15)
s_waitcnt lgkmcnt(3)
v_mfma_f32_32x32x16_bf16 v[64:79], v[140:143], a[76:79], v[64:79]
ds_read_b128 v[128:131], v200 offset:21504
buffer_load_dwordx4 a[108:111], v241, s[12:15], s76 offen offset:3072 sc1
v_mfma_f32_32x32x16_bf16 v[80:95], v[144:147], a[76:79], v[80:95]
ds_read_b128 v[132:135], v201 offset:21504
s_add_u32 s85, s86, 73728
s_mov_b32 m0, s85
s_nop 0
buffer_load_dwordx4 v241, s[4:7], s85 offen lds
v_mfma_f32_32x32x16_bf16 v[96:111], v[148:151], a[76:79], v[96:111]
ds_read_b128 v[136:139], v202 offset:21504
s_waitcnt vmcnt(15)
s_waitcnt lgkmcnt(3)
v_mfma_f32_32x32x16_bf16 v[64:79], v[152:155], a[80:83], v[64:79]
ds_read_b128 v[140:143], v200 offset:22528
s_add_u32 s76, s76, 4096
buffer_load_dwordx4 a[112:115], v241, s[12:15], s76 offen offset:0 sc1
v_mfma_f32_32x32x16_bf16 v[80:95], v[156:159], a[80:83], v[80:95]
ds_read_b128 v[144:147], v201 offset:22528
s_add_u32 s85, s86, 114688
s_mov_b32 m0, s85
s_nop 0
buffer_load_dwordx4 v241, s[4:7], s85 offen lds
v_mfma_f32_32x32x16_bf16 v[96:111], v[160:163], a[80:83], v[96:111]
ds_read_b128 v[148:151], v202 offset:22528
s_waitcnt vmcnt(15)
s_waitcnt lgkmcnt(3)
v_mfma_f32_32x32x16_bf16 v[64:79], v[128:131], a[84:87], v[64:79]
ds_read_b128 v[152:155], v200 offset:23552
buffer_load_dwordx4 a[116:119], v241, s[12:15], s76 offen offset:1024 sc1
v_mfma_f32_32x32x16_bf16 v[80:95], v[132:135], a[84:87], v[80:95]
ds_read_b128 v[156:159], v201 offset:23552
s_add_u32 s85, s86, 36864
s_mov_b32 m0, s85
s_nop 0
buffer_load_dwordx4 v241, s[4:7], s85 offen lds
v_mfma_f32_32x32x16_bf16 v[96:111], v[136:139], a[84:87], v[96:111]
ds_read_b128 v[160:163], v202 offset:23552
s_waitcnt vmcnt(15)
s_waitcnt vmcnt(14)
s_barrier
s_waitcnt lgkmcnt(3)
v_mfma_f32_32x32x16_bf16 v[64:79], v[140:143], a[88:91], v[64:79]
ds_read_b128 v[128:131], v200 offset:24576
buffer_load_dwordx4 a[120:123], v241, s[12:15], s76 offen offset:2048 sc1
v_mfma_f32_32x32x16_bf16 v[80:95], v[144:147], a[88:91], v[80:95]
ds_read_b128 v[132:135], v201 offset:24576
s_add_u32 s85, s86, 77824
s_mov_b32 m0, s85
s_nop 0
buffer_load_dwordx4 v241, s[4:7], s85 offen lds
v_mfma_f32_32x32x16_bf16 v[96:111], v[148:151], a[88:91], v[96:111]
ds_read_b128 v[136:139], v202 offset:24576
s_waitcnt vmcnt(15)
s_waitcnt lgkmcnt(3)
v_mfma_f32_32x32x16_bf16 v[64:79], v[152:155], a[92:95], v[64:79]
ds_read_b128 v[140:143], v200 offset:25600
buffer_load_dwordx4 a[124:127], v241, s[12:15], s76 offen offset:3072 sc1
v_mfma_f32_32x32x16_bf16 v[80:95], v[156:159], a[92:95], v[80:95]
ds_read_b128 v[144:147], v201 offset:25600
s_add_u32 s85, s86, 118784
s_mov_b32 m0, s85
s_nop 0
buffer_load_dwordx4 v241, s[4:7], s85 offen lds
v_mfma_f32_32x32x16_bf16 v[96:111], v[160:163], a[92:95], v[96:111]
ds_read_b128 v[148:151], v202 offset:25600
s_waitcnt vmcnt(15)
s_waitcnt lgkmcnt(3)
v_mfma_f32_32x32x16_bf16 v[64:79], v[128:131], a[96:99], v[64:79]
ds_read_b128 v[152:155], v200 offset:26624
s_add_u32 s76, s76, 4096
buffer_load_dwordx4 a[128:131], v241, s[12:15], s76 offen offset:0 sc1
v_mfma_f32_32x32x16_bf16 v[80:95], v[132:135], a[96:99], v[80:95]
ds_read_b128 v[156:159], v201 offset:26624
s_add_u32 s85, s86, 122880
s_mov_b32 m0, s85
s_nop 0
buffer_load_dwordx4 v241, s[4:7], s85 offen lds
buffer_load_dwordx2 v[16:17], v1, s[12:15], s77 offen offset:0 sc1
buffer_load_dwordx2 v[18:19], v1, s[12:15], s77 offen offset:512 sc1
buffer_load_dwordx2 v[20:21], v1, s[12:15], s77 offen offset:1024 sc1
buffer_load_dwordx2 v[22:23], v1, s[12:15], s77 offen offset:1536 sc1
v_mfma_f32_32x32x16_bf16 v[96:111], v[136:139], a[96:99], v[96:111]
ds_read_b128 v[160:163], v202 offset:26624
buffer_load_dwordx4 a[132:135], v241, s[12:15], s76 offen offset:1024 sc1
s_waitcnt vmcnt(20)
s_waitcnt lgkmcnt(3)
v_mfma_f32_32x32x16_bf16 v[64:79], v[140:143], a[100:103], v[64:79]
ds_read_b128 v[128:131], v200 offset:27648
buffer_load_dwordx4 a[136:139], v241, s[12:15], s76 offen offset:2048 sc1
v_mfma_f32_32x32x16_bf16 v[80:95], v[144:147], a[100:103], v[80:95]
ds_read_b128 v[132:135], v201 offset:27648
s_add_u32 s85, s86, 126976
s_mov_b32 m0, s85
s_nop 0
buffer_load_dwordx4 v241, s[4:7], s85 offen lds
v_mfma_f32_32x32x16_bf16 v[96:111], v[148:151], a[100:103], v[96:111]
ds_read_b128 v[136:139], v202 offset:27648
buffer_load_dwordx4 a[140:143], v241, s[12:15], s76 offen offset:3072 sc1
s_waitcnt vmcnt(21)
s_waitcnt vmcnt(22)
s_barrier
s_waitcnt lgkmcnt(3)
v_mfma_f32_32x32x16_bf16 v[64:79], v[152:155], a[104:107], v[64:79]
ds_read_b128 v[140:143], v200 offset:28672
s_add_u32 s76, s76, 4096
buffer_load_dwordx4 a[144:147], v241, s[12:15], s76 offen offset:0 sc1
v_mfma_f32_32x32x16_bf16 v[80:95], v[156:159], a[104:107], v[80:95]
ds_read_b128 v[144:147], v201 offset:28672
s_add_u32 s85, s86, 131072
s_mov_b32 m0, s85
s_nop 0
buffer_load_dwordx4 v241, s[4:7], s85 offen lds
v_mfma_f32_32x32x16_bf16 v[96:111], v[160:163], a[104:107], v[96:111]
ds_read_b128 v[148:151], v202 offset:28672
buffer_load_dwordx4 a[148:151], v241, s[12:15], s76 offen offset:1024 sc1
s_waitcnt vmcnt(22)
s_waitcnt lgkmcnt(3)
v_mfma_f32_32x32x16_bf16 v[64:79], v[128:131], a[108:111], v[64:79]
ds_read_b128 v[152:155], v200 offset:29696
buffer_load_dwordx4 a[152:155], v241, s[12:15], s76 offen offset:2048 sc1
v_mfma_f32_32x32x16_bf16 v[80:95], v[132:135], a[108:111], v[80:95]
ds_read_b128 v[156:159], v201 offset:29696
s_add_u32 s85, s86, 135168
s_mov_b32 m0, s85
s_nop 0
buffer_load_dwordx4 v241, s[4:7], s85 offen lds
v_mfma_f32_32x32x16_bf16 v[96:111], v[136:139], a[108:111], v[96:111]
ds_read_b128 v[160:163], v202 offset:29696
buffer_load_dwordx4 a[156:159], v241, s[12:15], s76 offen offset:3072 sc1
s_waitcnt vmcnt(23)
s_waitcnt lgkmcnt(3)
v_mfma_f32_32x32x16_bf16 v[64:79], v[140:143], a[112:115], v[64:79]
ds_read_b128 v[128:131], v200 offset:30720
v_mfma_f32_32x32x16_bf16 v[80:95], v[144:147], a[112:115], v[80:95]
ds_read_b128 v[132:135], v201 offset:30720
s_add_u32 s85, s86, 139264
s_mov_b32 m0, s85
s_nop 0
buffer_load_dwordx4 v241, s[4:7], s85 offen lds
v_mfma_f32_32x32x16_bf16 v[96:111], v[148:151], a[112:115], v[96:111]
ds_read_b128 v[136:139], v202 offset:30720
s_waitcnt vmcnt(22)
s_waitcnt lgkmcnt(3)
v_mfma_f32_32x32x16_bf16 v[64:79], v[152:155], a[116:119], v[64:79]
ds_read_b128 v[140:143], v200 offset:31744
v_mfma_f32_32x32x16_bf16 v[80:95], v[156:159], a[116:119], v[80:95]
ds_read_b128 v[144:147], v201 offset:31744
s_add_u32 s85, s86, 143360
s_mov_b32 m0, s85
s_nop 0
buffer_load_dwordx4 v241, s[4:7], s85 offen lds
v_mfma_f32_32x32x16_bf16 v[96:111], v[160:163], a[116:119], v[96:111]
ds_read_b128 v[148:151], v202 offset:31744
s_waitcnt vmcnt(21)
s_waitcnt vmcnt(24)
s_barrier
s_waitcnt lgkmcnt(3)
v_mfma_f32_32x32x16_bf16 v[64:79], v[128:131], a[120:123], v[64:79]
ds_read_b128 v[152:155], v200 offset:32768
v_mfma_f32_32x32x16_bf16 v[80:95], v[132:135], a[120:123], v[80:95]
ds_read_b128 v[156:159], v201 offset:32768
s_add_u32 s85, s86, 147456
s_mov_b32 m0, s85
s_nop 0
buffer_load_dwordx4 v241, s[4:7], s85 offen lds
v_mfma_f32_32x32x16_bf16 v[96:111], v[136:139], a[120:123], v[96:111]
ds_read_b128 v[160:163], v202 offset:32768
s_waitcnt vmcnt(20)
s_waitcnt lgkmcnt(3)
v_mfma_f32_32x32x16_bf16 v[64:79], v[140:143], a[124:127], v[64:79]
ds_read_b128 v[128:131], v200 offset:33792
v_mfma_f32_32x32x16_bf16 v[80:95], v[144:147], a[124:127], v[80:95]
ds_read_b128 v[132:135], v201 offset:33792
s_min_u32 s86, s86, 1024
s_add_u32 s85, s86, 151552
s_mov_b32 m0, s85
s_nop 0
buffer_load_dwordx4 v241, s[4:7], s85 offen lds
v_mfma_f32_32x32x16_bf16 v[96:111], v[148:151], a[124:127], v[96:111]
ds_read_b128 v[136:139], v202 offset:33792
s_waitcnt vmcnt(19)
s_waitcnt lgkmcnt(3)
v_mfma_f32_32x32x16_bf16 v[64:79], v[152:155], a[128:131], v[64:79]
ds_read_b128 v[140:143], v200 offset:34816
v_mfma_f32_32x32x16_bf16 v[80:95], v[156:159], a[128:131], v[80:95]
ds_read_b128 v[144:147], v201 offset:34816
v_mfma_f32_32x32x16_bf16 v[96:111], v[160:163], a[128:131], v[96:111]
ds_read_b128 v[148:151], v202 offset:34816
s_waitcnt vmcnt(13)
s_waitcnt lgkmcnt(3)
v_mfma_f32_32x32x16_bf16 v[64:79], v[128:131], a[132:135], v[64:79]
ds_read_b128 v[152:155], v200 offset:35840
v_mfma_f32_32x32x16_bf16 v[80:95], v[132:135], a[132:135], v[80:95]
ds_read_b128 v[156:159], v201 offset:35840
s_add_u32 s28, s93, 0
buffer_load_dword v237, v212, s[8:11], s28 offen
v_mfma_f32_32x32x16_bf16 v[96:111], v[136:139], a[132:135], v[96:111]
ds_read_b128 v[160:163], v202 offset:35840
s_waitcnt vmcnt(13)
s_waitcnt vmcnt(21)
s_barrier
s_waitcnt lgkmcnt(3)
v_mfma_f32_32x32x16_bf16 v[64:79], v[140:143], a[136:139], v[64:79]
ds_read_b128 v[128:131], v200 offset:36864
v_mfma_f32_32x32x16_bf16 v[80:95], v[144:147], a[136:139], v[80:95]
ds_read_b128 v[132:135], v201 offset:36864
v_mfma_f32_32x32x16_bf16 v[96:111], v[148:151], a[136:139], v[96:111]
ds_read_b128 v[136:139], v202 offset:36864
s_waitcnt vmcnt(15)
v_add_f32 v16, v16, v18
v_add_f32 v17, v17, v19
v_add_f32 v20, v20, v22
v_add_f32 v21, v21, v23
v_add_f32 v16, v16, v20
v_add_f32 v17, v17, v21
s_waitcnt vmcnt(11)
s_waitcnt lgkmcnt(3)
v_mfma_f32_32x32x16_bf16 v[64:79], v[152:155], a[140:143], v[64:79]
ds_read_b128 v[140:143], v200 offset:37888
v_mfma_f32_32x32x16_bf16 v[80:95], v[156:159], a[140:143], v[80:95]
ds_read_b128 v[144:147], v201 offset:37888
s_add_u32 s28, s93, 8192
buffer_load_dword v237, v213, s[8:11], s28 offen
v_mfma_f32_32x32x16_bf16 v[96:111], v[160:163], a[140:143], v[96:111]
ds_read_b128 v[148:151], v202 offset:37888
v_mov_b32 v18, v16
s_nop 1
v_permlane32_swap_b32 v16, v18
v_add_f32 v16, v16, v18
v_mov_b32 v19, v17
s_nop 1
v_permlane32_swap_b32 v17, v19
v_add_f32 v17, v17, v19
s_waitcnt vmcnt(11)
s_waitcnt lgkmcnt(3)
v_mfma_f32_32x32x16_bf16 v[64:79], v[128:131], a[144:147], v[64:79]
ds_read_b128 v[152:155], v200 offset:38912
v_mfma_f32_32x32x16_bf16 v[80:95], v[132:135], a[144:147], v[80:95]
ds_read_b128 v[156:159], v201 offset:38912
v_mfma_f32_32x32x16_bf16 v[96:111], v[136:139], a[144:147], v[96:111]
ds_read_b128 v[160:163], v202 offset:38912
v_mul_f32 v16, 0x3acccccd, v16
v_mul_f32 v17, 0x3acccccd, v17
v_fma_f32 v17, -v16, v16, v17
v_max_f32 v17, 0, v17
v_add_f32 v17, 0x3727c5ac, v17
v_rsq_f32 v18, v17
s_waitcnt vmcnt(9)
s_waitcnt lgkmcnt(3)
v_mfma_f32_32x32x16_bf16 v[64:79], v[140:143], a[148:151], v[64:79]
ds_read_b128 v[128:131], v200 offset:39936
v_mfma_f32_32x32x16_bf16 v[80:95], v[144:147], a[148:151], v[80:95]
ds_read_b128 v[132:135], v201 offset:39936
s_add_u32 s28, s93, 16384
buffer_load_dword v237, v214, s[8:11], s28 offen
v_mfma_f32_32x32x16_bf16 v[96:111], v[148:151], a[148:151], v[96:111]
ds_read_b128 v[136:139], v202 offset:39936
v_sub_f32 v20, 0, v16
v_mul_f32 v22, 0x3ea52b5c, v18
s_and_b32 s28, s23, 1
s_lshl_b32 s28, s28, 9
s_add_u32 s28, s28, 155648
v_lshlrev_b32 v1, 4, v252
v_add_u32 v1, s28, v1
s_waitcnt vmcnt(9)
s_waitcnt lgkmcnt(3)
v_mfma_f32_32x32x16_bf16 v[64:79], v[152:155], a[152:155], v[64:79]
v_mfma_f32_32x32x16_bf16 v[80:95], v[156:159], a[152:155], v[80:95]
v_mfma_f32_32x32x16_bf16 v[96:111], v[160:163], a[152:155], v[96:111]
ds_read_b128 v[48:51], v1 offset:0
ds_read_b128 v[52:55], v1 offset:32
ds_read_b128 v[56:59], v1 offset:96
ds_read_b128 v[60:63], v1 offset:128
s_waitcnt vmcnt(7)
s_waitcnt lgkmcnt(4)
v_mfma_f32_32x32x16_bf16 v[64:79], v[128:131], a[156:159], v[64:79]
v_mfma_f32_32x32x16_bf16 v[80:95], v[132:135], a[156:159], v[80:95]
s_add_u32 s28, s93, 24576
buffer_load_dword v237, v215, s[8:11], s28 offen
v_mfma_f32_32x32x16_bf16 v[96:111], v[136:139], a[156:159], v[96:111]
s_waitcnt vmcnt(4)
s_branch L_gemmend_10
L_nostream_9:
buffer_load_dwordx4 a[0:3], v241, s[12:15], s76 offen offset:0 sc1
buffer_load_dwordx4 a[4:7], v241, s[12:15], s76 offen offset:1024 sc1
buffer_load_dwordx4 a[8:11], v241, s[12:15], s76 offen offset:2048 sc1
buffer_load_dwordx4 a[12:15], v241, s[12:15], s76 offen offset:3072 sc1
s_add_u32 s76, s76, 4096
buffer_load_dwordx4 a[16:19], v241, s[12:15], s76 offen offset:0 sc1
buffer_load_dwordx4 a[20:23], v241, s[12:15], s76 offen offset:1024 sc1
buffer_load_dwordx4 a[24:27], v241, s[12:15], s76 offen offset:2048 sc1
buffer_load_dwordx4 a[28:31], v241, s[12:15], s76 offen offset:3072 sc1
s_and_b32 s28, s23, 1
s_lshl_b32 s28, s28, 3
s_add_u32 s28, s28, s59
s_mul_i32 s28, s28, 0x19000
s_add_u32 s28, s28, 58720256
s_add_u32 s8, s56, s28
s_addc_u32 s9, s57, 0
s_mov_b32 s10, 102400
s_mov_b32 s11, 0x20000
s_add_u32 s28, s23, 1
s_and_b32 s29, s28, 1
s_mul_i32 s29, s29, 0x280000
s_mul_i32 s30, s21, 0x28000
s_add_u32 s29, s29, s30
s_add_u32 s29, s29, 52428800
s_add_u32 s80, s56, s29
s_addc_u32 s81, s57, 0
s_cmp_lt_u32 s23, 3
s_cselect_b32 s82, 153600, 0
s_mov_b32 s83, 0x20000
s_and_b32 s28, s20, 1
s_lshl_b32 s89, s28, 13
s_and_b32 s28, s20, 1
s_lshl_b32 s28, s28, 1
s_add_u32 s28, s28, s58
s_mul_i32 s93, s28, 25600
s_lshl_b32 s86, s22, 10
s_waitcnt vmcnt(7)
s_waitcnt lgkmcnt(0)
s_barrier
ds_read_b128 v[128:131], v200 offset:0
ds_read_b128 v[132:135], v201 offset:0
ds_read_b128 v[136:139], v202 offset:0
ds_read_b128 v[140:143], v200 offset:1024
ds_read_b128 v[144:147], v201 offset:1024
ds_read_b128 v[148:151], v202 offset:1024
s_waitcnt vmcnt(7)
s_waitcnt lgkmcnt(3)
v_mfma_f32_32x32x16_bf16 v[64:79], v[128:131], a[0:3], 0
ds_read_b128 v[152:155], v200 offset:2048
s_add_u32 s76, s76, 4096
buffer_load_dwordx4 a[32:35], v241, s[12:15], s76 offen offset:0 sc1
v_mfma_f32_32x32x16_bf16 v[80:95], v[132:135], a[0:3], 0
ds_read_b128 v[156:159], v201 offset:2048
v_mfma_f32_32x32x16_bf16 v[96:111], v[136:139], a[0:3], 0
ds_read_b128 v[160:163], v202 offset:2048
buffer_load_dwordx4 a[36:39], v241, s[12:15], s76 offen offset:1024 sc1
s_waitcnt vmcnt(8)
s_waitcnt lgkmcnt(3)
v_mfma_f32_32x32x16_bf16 v[64:79], v[140:143], a[4:7], v[64:79]
ds_read_b128 v[128:131], v200 offset:3072
buffer_load_dwordx4 a[40:43], v241, s[12:15], s76 offen offset:2048 sc1
v_mfma_f32_32x32x16_bf16 v[80:95], v[144:147], a[4:7], v[80:95]
ds_read_b128 v[132:135], v201 offset:3072
v_mfma_f32_32x32x16_bf16 v[96:111], v[148:151], a[4:7], v[96:111]
ds_read_b128 v[136:139], v202 offset:3072
buffer_load_dwordx4 a[44:47], v241, s[12:15], s76 offen offset:3072 sc1
s_waitcnt vmcnt(9)
s_waitcnt lgkmcnt(3)
v_mfma_f32_32x32x16_bf16 v[64:79], v[152:155], a[8:11], v[64:79]
ds_read_b128 v[140:143], v200 offset:4096
s_add_u32 s76, s76, 4096
buffer_load_dwordx4 a[48:51], v241, s[12:15], s76 offen offset:0 sc1
v_mfma_f32_32x32x16_bf16 v[80:95], v[156:159], a[8:11], v[80:95]
ds_read_b128 v[144:147], v201 offset:4096
v_mfma_f32_32x32x16_bf16 v[96:111], v[160:163], a[8:11], v[96:111]
ds_read_b128 v[148:151], v202 offset:4096
buffer_load_dwordx4 a[52:55], v241, s[12:15], s76 offen offset:1024 sc1
s_waitcnt vmcnt(10)
s_waitcnt lgkmcnt(3)
v_mfma_f32_32x32x16_bf16 v[64:79], v[128:131], a[12:15], v[64:79]
ds_read_b128 v[152:155], v200 offset:5120
buffer_load_dwordx4 a[56:59], v241, s[12:15], s76 offen offset:2048 sc1
v_mfma_f32_32x32x16_bf16 v[80:95], v[132:135], a[12:15], v[80:95]
ds_read_b128 v[156:159], v201 offset:5120
v_mfma_f32_32x32x16_bf16 v[96:111], v[136:139], a[12:15], v[96:111]
ds_read_b128 v[160:163], v202 offset:5120
buffer_load_dwordx4 a[60:63], v241, s[12:15], s76 offen offset:3072 sc1
s_waitcnt vmcnt(11)
s_waitcnt lgkmcnt(3)
v_mfma_f32_32x32x16_bf16 v[64:79], v[140:143], a[16:19], v[64:79]
ds_read_b128 v[128:131], v200 offset:6144
s_add_u32 s76, s76, 4096
buffer_load_dwordx4 a[64:67], v241, s[12:15], s76 offen offset:0 sc1
v_mfma_f32_32x32x16_bf16 v[80:95], v[144:147], a[16:19], v[80:95]
ds_read_b128 v[132:135], v201 offset:6144
s_add_u32 s28, s93, 0
buffer_load_dword v237, v212, s[8:11], s28 offen
v_mfma_f32_32x32x16_bf16 v[96:111], v[148:151], a[16:19], v[96:111]
ds_read_b128 v[136:139], v202 offset:6144
buffer_load_dwordx4 a[68:71], v241, s[12:15], s76 offen offset:1024 sc1
s_waitcnt vmcnt(13)
s_waitcnt lgkmcnt(3)
v_mfma_f32_32x32x16_bf16 v[64:79], v[152:155], a[20:23], v[64:79]
ds_read_b128 v[140:143], v200 offset:7168
buffer_load_dwordx4 a[72:75], v241, s[12:15], s76 offen offset:2048 sc1
v_mfma_f32_32x32x16_bf16 v[80:95], v[156:159], a[20:23], v[80:95]
ds_read_b128 v[144:147], v201 offset:7168
v_mfma_f32_32x32x16_bf16 v[96:111], v[160:163], a[20:23], v[96:111]
ds_read_b128 v[148:151], v202 offset:7168
s_waitcnt vmcnt(13)
s_waitcnt lgkmcnt(3)
v_mfma_f32_32x32x16_bf16 v[64:79], v[128:131], a[24:27], v[64:79]
ds_read_b128 v[152:155], v200 offset:8192
buffer_load_dwordx4 a[76:79], v241, s[12:15], s76 offen offset:3072 sc1
v_mfma_f32_32x32x16_bf16 v[80:95], v[132:135], a[24:27], v[80:95]
ds_read_b128 v[156:159], v201 offset:8192
v_mfma_f32_32x32x16_bf16 v[96:111], v[136:139], a[24:27], v[96:111]
ds_read_b128 v[160:163], v202 offset:8192
s_waitcnt vmcnt(13)
s_waitcnt lgkmcnt(3)
v_mfma_f32_32x32x16_bf16 v[64:79], v[140:143], a[28:31], v[64:79]
ds_read_b128 v[128:131], v200 offset:9216
s_add_u32 s76, s76, 4096
buffer_load_dwordx4 a[80:83], v241, s[12:15], s76 offen offset:0 sc1
v_mfma_f32_32x32x16_bf16 v[80:95], v[144:147], a[28:31], v[80:95]
ds_read_b128 v[132:135], v201 offset:9216
v_mfma_f32_32x32x16_bf16 v[96:111], v[148:151], a[28:31], v[96:111]
ds_read_b128 v[136:139], v202 offset:9216
s_waitcnt vmcnt(13)
s_waitcnt lgkmcnt(3)
v_mfma_f32_32x32x16_bf16 v[64:79], v[152:155], a[32:35], v[64:79]
ds_read_b128 v[140:143], v200 offset:10240
buffer_load_dwordx4 a[84:87], v241, s[12:15], s76 offen offset:1024 sc1
v_mfma_f32_32x32x16_bf16 v[80:95], v[156:159], a[32:35], v[80:95]
ds_read_b128 v[144:147], v201 offset:10240
v_mfma_f32_32x32x16_bf16 v[96:111], v[160:163], a[32:35], v[96:111]
ds_read_b128 v[148:151], v202 offset:10240
s_waitcnt vmcnt(13)
s_waitcnt lgkmcnt(3)
v_mfma_f32_32x32x16_bf16 v[64:79], v[128:131], a[36:39], v[64:79]
ds_read_b128 v[152:155], v200 offset:11264
buffer_load_dwordx4 a[88:91], v241, s[12:15], s76 offen offset:2048 sc1
v_mfma_f32_32x32x16_bf16 v[80:95], v[132:135], a[36:39], v[80:95]
ds_read_b128 v[156:159], v201 offset:11264
v_mfma_f32_32x32x16_bf16 v[96:111], v[136:139], a[36:39], v[96:111]
ds_read_b128 v[160:163], v202 offset:11264
s_waitcnt vmcnt(13)
s_waitcnt lgkmcnt(3)
v_mfma_f32_32x32x16_bf16 v[64:79], v[140:143], a[40:43], v[64:79]
ds_read_b128 v[128:131], v200 offset:12288
buffer_load_dwordx4 a[92:95], v241, s[12:15], s76 offen offset:3072 sc1
v_mfma_f32_32x32x16_bf16 v[80:95], v[144:147], a[40:43], v[80:95]
ds_read_b128 v[132:135], v201 offset:12288
v_mfma_f32_32x32x16_bf16 v[96:111], v[148:151], a[40:43], v[96:111]
ds_read_b128 v[136:139], v202 offset:12288
s_waitcnt vmcnt(13)
s_waitcnt lgkmcnt(3)
v_mfma_f32_32x32x16_bf16 v[64:79], v[152:155], a[44:47], v[64:79]
ds_read_b128 v[140:143], v200 offset:13312
s_add_u32 s76, s76, 4096
buffer_load_dwordx4 a[96:99], v241, s[12:15], s76 offen offset:0 sc1
v_mfma_f32_32x32x16_bf16 v[80:95], v[156:159], a[44:47], v[80:95]
ds_read_b128 v[144:147], v201 offset:13312
s_add_u32 s28, s93, 8192
buffer_load_dword v237, v213, s[8:11], s28 offen
v_mfma_f32_32x32x16_bf16 v[96:111], v[160:163], a[44:47], v[96:111]
ds_read_b128 v[148:151], v202 offset:13312
s_waitcnt vmcnt(14)
s_waitcnt lgkmcnt(3)
v_mfma_f32_32x32x16_bf16 v[64:79], v[128:131], a[48:51], v[64:79]
ds_read_b128 v[152:155], v200 offset:14336
buffer_load_dwordx4 a[100:103], v241, s[12:15], s76 offen offset:1024 sc1
v_mfma_f32_32x32x16_bf16 v[80:95], v[132:135], a[48:51], v[80:95]
ds_read_b128 v[156:159], v201 offset:14336
v_mfma_f32_32x32x16_bf16 v[96:111], v[136:139], a[48:51], v[96:111]
ds_read_b128 v[160:163], v202 offset:14336
s_waitcnt vmcnt(14)
s_waitcnt lgkmcnt(3)
v_mfma_f32_32x32x16_bf16 v[64:79], v[140:143], a[52:55], v[64:79]
ds_read_b128 v[128:131], v200 offset:15360
buffer_load_dwordx4 a[104:107], v241, s[12:15], s76 offen offset:2048 sc1
v_mfma_f32_32x32x16_bf16 v[80:95], v[144:147], a[52:55], v[80:95]
ds_read_b128 v[132:135], v201 offset:15360
v_mfma_f32_32x32x16_bf16 v[96:111], v[148:151], a[52:55], v[96:111]
ds_read_b128 v[136:139], v202 offset:15360
s_waitcnt vmcnt(14)
s_waitcnt lgkmcnt(3)
v_mfma_f32_32x32x16_bf16 v[64:79], v[152:155], a[56:59], v[64:79]
ds_read_b128 v[140:143], v200 offset:16384
buffer_load_dwordx4 a[108:111], v241, s[12:15], s76 offen offset:3072 sc1
v_mfma_f32_32x32x16_bf16 v[80:95], v[156:159], a[56:59], v[80:95]
ds_read_b128 v[144:147], v201 offset:16384
v_mfma_f32_32x32x16_bf16 v[96:111], v[160:163], a[56:59], v[96:111]
ds_read_b128 v[148:151], v202 offset:16384
s_waitcnt vmcnt(14)
s_waitcnt lgkmcnt(3)
v_mfma_f32_32x32x16_bf16 v[64:79], v[128:131], a[60:63], v[64:79]
ds_read_b128 v[152:155], v200 offset:17408
s_add_u32 s76, s76, 4096
buffer_load_dwordx4 a[112:115], v241, s[12:15], s76 offen offset:0 sc1
v_mfma_f32_32x32x16_bf16 v[80:95], v[132:135], a[60:63], v[80:95]
ds_read_b128 v[156:159], v201 offset:17408
v_mfma_f32_32x32x16_bf16 v[96:111], v[136:139], a[60:63], v[96:111]
ds_read_b128 v[160:163], v202 offset:17408
s_waitcnt vmcnt(14)
s_waitcnt lgkmcnt(3)
v_mfma_f32_32x32x16_bf16 v[64:79], v[140:143], a[64:67], v[64:79]
ds_read_b128 v[128:131], v200 offset:18432
buffer_load_dwordx4 a[116:119], v241, s[12:15], s76 offen offset:1024 sc1
v_mfma_f32_32x32x16_bf16 v[80:95], v[144:147], a[64:67], v[80:95]
ds_read_b128 v[132:135], v201 offset:18432
v_mfma_f32_32x32x16_bf16 v[96:111], v[148:151], a[64:67], v[96:111]
ds_read_b128 v[136:139], v202 offset:18432
s_waitcnt vmcnt(13)
s_waitcnt lgkmcnt(3)
v_mfma_f32_32x32x16_bf16 v[64:79], v[152:155], a[68:71], v[64:79]
ds_read_b128 v[140:143], v200 offset:19456
buffer_load_dwordx4 a[120:123], v241, s[12:15], s76 offen offset:2048 sc1
v_mfma_f32_32x32x16_bf16 v[80:95], v[156:159], a[68:71], v[80:95]
ds_read_b128 v[144:147], v201 offset:19456
v_mfma_f32_32x32x16_bf16 v[96:111], v[160:163], a[68:71], v[96:111]
ds_read_b128 v[148:151], v202 offset:19456
s_waitcnt vmcnt(13)
s_waitcnt lgkmcnt(3)
v_mfma_f32_32x32x16_bf16 v[64:79], v[128:131], a[72:75], v[64:79]
ds_read_b128 v[152:155], v200 offset:20480
buffer_load_dwordx4 a[124:127], v241, s[12:15], s76 offen offset:3072 sc1
v_mfma_f32_32x32x16_bf16 v[80:95], v[132:135], a[72:75], v[80:95]
ds_read_b128 v[156:159], v201 offset:20480
s_add_u32 s28, s93, 16384
buffer_load_dword v237, v214, s[8:11], s28 offen
v_mfma_f32_32x32x16_bf16 v[96:111], v[136:139], a[72:75], v[96:111]
ds_read_b128 v[160:163], v202 offset:20480
s_waitcnt vmcnt(14)
s_waitcnt lgkmcnt(3)
v_mfma_f32_32x32x16_bf16 v[64:79], v[140:143], a[76:79], v[64:79]
ds_read_b128 v[128:131], v200 offset:21504
s_add_u32 s76, s76, 4096
buffer_load_dwordx4 a[128:131], v241, s[12:15], s76 offen offset:0 sc1
v_mfma_f32_32x32x16_bf16 v[80:95], v[144:147], a[76:79], v[80:95]
ds_read_b128 v[132:135], v201 offset:21504
v_mfma_f32_32x32x16_bf16 v[96:111], v[148:151], a[76:79], v[96:111]
ds_read_b128 v[136:139], v202 offset:21504
s_waitcnt vmcnt(14)
s_waitcnt lgkmcnt(3)
v_mfma_f32_32x32x16_bf16 v[64:79], v[152:155], a[80:83], v[64:79]
ds_read_b128 v[140:143], v200 offset:22528
buffer_load_dwordx4 a[132:135], v241, s[12:15], s76 offen offset:1024 sc1
v_mfma_f32_32x32x16_bf16 v[80:95], v[156:159], a[80:83], v[80:95]
ds_read_b128 v[144:147], v201 offset:22528
v_mfma_f32_32x32x16_bf16 v[96:111], v[160:163], a[80:83], v[96:111]
ds_read_b128 v[148:151], v202 offset:22528
s_waitcnt vmcnt(14)
s_waitcnt lgkmcnt(3)
v_mfma_f32_32x32x16_bf16 v[64:79], v[128:131], a[84:87], v[64:79]
ds_read_b128 v[152:155], v200 offset:23552
buffer_load_dwordx4 a[136:139], v241, s[12:15], s76 offen offset:2048 sc1
v_mfma_f32_32x32x16_bf16 v[80:95], v[132:135], a[84:87], v[80:95]
ds_read_b128 v[156:159], v201 offset:23552
v_mfma_f32_32x32x16_bf16 v[96:111], v[136:139], a[84:87], v[96:111]
ds_read_b128 v[160:163], v202 offset:23552
s_waitcnt vmcnt(14)
s_waitcnt lgkmcnt(3)
v_mfma_f32_32x32x16_bf16 v[64:79], v[140:143], a[88:91], v[64:79]
ds_read_b128 v[128:131], v200 offset:24576
buffer_load_dwordx4 a[140:143], v241, s[12:15], s76 offen offset:3072 sc1
v_mfma_f32_32x32x16_bf16 v[80:95], v[144:147], a[88:91], v[80:95]
ds_read_b128 v[132:135], v201 offset:24576
v_mfma_f32_32x32x16_bf16 v[96:111], v[148:151], a[88:91], v[96:111]
ds_read_b128 v[136:139], v202 offset:24576
s_waitcnt vmcnt(14)
s_waitcnt lgkmcnt(3)
v_mfma_f32_32x32x16_bf16 v[64:79], v[152:155], a[92:95], v[64:79]
ds_read_b128 v[140:143], v200 offset:25600
s_add_u32 s76, s76, 4096
buffer_load_dwordx4 a[144:147], v241, s[12:15], s76 offen offset:0 sc1
v_mfma_f32_32x32x16_bf16 v[80:95], v[156:159], a[92:95], v[80:95]
ds_read_b128 v[144:147], v201 offset:25600
v_mfma_f32_32x32x16_bf16 v[96:111], v[160:163], a[92:95], v[96:111]
ds_read_b128 v[148:151], v202 offset:25600
s_waitcnt vmcnt(14)
s_waitcnt lgkmcnt(3)
v_mfma_f32_32x32x16_bf16 v[64:79], v[128:131], a[96:99], v[64:79]
ds_read_b128 v[152:155], v200 offset:26624
buffer_load_dwordx4 a[148:151], v241, s[12:15], s76 offen offset:1024 sc1
v_mfma_f32_32x32x16_bf16 v[80:95], v[132:135], a[96:99], v[80:95]
ds_read_b128 v[156:159], v201 offset:26624
buffer_load_dwordx2 v[16:17], v1, s[12:15], s77 offen offset:0 sc1
buffer_load_dwordx2 v[18:19], v1, s[12:15], s77 offen offset:512 sc1
buffer_load_dwordx2 v[20:21], v1, s[12:15], s77 offen offset:1024 sc1
buffer_load_dwordx2 v[22:23], v1, s[12:15], s77 offen offset:1536 sc1
v_mfma_f32_32x32x16_bf16 v[96:111], v[136:139], a[96:99], v[96:111]
ds_read_b128 v[160:163], v202 offset:26624
s_waitcnt vmcnt(17)
s_waitcnt lgkmcnt(3)
v_mfma_f32_32x32x16_bf16 v[64:79], v[140:143], a[100:103], v[64:79]
ds_read_b128 v[128:131], v200 offset:27648
buffer_load_dwordx4 a[152:155], v241, s[12:15], s76 offen offset:2048 sc1
v_mfma_f32_32x32x16_bf16 v[80:95], v[144:147], a[100:103], v[80:95]
ds_read_b128 v[132:135], v201 offset:27648
s_add_u32 s28, s93, 24576
buffer_load_dword v237, v215, s[8:11], s28 offen
v_mfma_f32_32x32x16_bf16 v[96:111], v[148:151], a[100:103], v[96:111]
ds_read_b128 v[136:139], v202 offset:27648
s_waitcnt vmcnt(18)
s_waitcnt lgkmcnt(3)
v_mfma_f32_32x32x16_bf16 v[64:79], v[152:155], a[104:107], v[64:79]
ds_read_b128 v[140:143], v200 offset:28672
buffer_load_dwordx4 a[156:159], v241, s[12:15], s76 offen offset:3072 sc1
v_mfma_f32_32x32x16_bf16 v[80:95], v[156:159], a[104:107], v[80:95]
ds_read_b128 v[144:147], v201 offset:28672
s_add_u32 s85, s86, 122880
s_mov_b32 m0, s85
s_nop 0
buffer_load_dwordx4 v241, s[4:7], s85 offen lds
v_mfma_f32_32x32x16_bf16 v[96:111], v[160:163], a[104:107], v[96:111]
ds_read_b128 v[148:151], v202 offset:28672
s_waitcnt vmcnt(19)
s_waitcnt lgkmcnt(3)
v_mfma_f32_32x32x16_bf16 v[64:79], v[128:131], a[108:111], v[64:79]
ds_read_b128 v[152:155], v200 offset:29696
v_mfma_f32_32x32x16_bf16 v[80:95], v[132:135], a[108:111], v[80:95]
ds_read_b128 v[156:159], v201 offset:29696
s_add_u32 s85, s86, 126976
s_mov_b32 m0, s85
s_nop 0
buffer_load_dwordx4 v241, s[4:7], s85 offen lds
v_mfma_f32_32x32x16_bf16 v[96:111], v[136:139], a[108:111], v[96:111]
ds_read_b128 v[160:163], v202 offset:29696
s_waitcnt vmcnt(19)
s_waitcnt lgkmcnt(3)
v_mfma_f32_32x32x16_bf16 v[64:79], v[140:143], a[112:115], v[64:79]
ds_read_b128 v[128:131], v200 offset:30720
v_mfma_f32_32x32x16_bf16 v[80:95], v[144:147], a[112:115], v[80:95]
ds_read_b128 v[132:135], v201 offset:30720
s_add_u32 s85, s86, 131072
s_mov_b32 m0, s85
s_nop 0
buffer_load_dwordx4 v241, s[4:7], s85 offen lds
v_mfma_f32_32x32x16_bf16 v[96:111], v[148:151], a[112:115], v[96:111]
ds_read_b128 v[136:139], v202 offset:30720
s_waitcnt vmcnt(19)
s_waitcnt lgkmcnt(3)
v_mfma_f32_32x32x16_bf16 v[64:79], v[152:155], a[116:119], v[64:79]
ds_read_b128 v[140:143], v200 offset:31744
v_mfma_f32_32x32x16_bf16 v[80:95], v[156:159], a[116:119], v[80:95]
ds_read_b128 v[144:147], v201 offset:31744
s_add_u32 s85, s86, 135168
s_mov_b32 m0, s85
s_nop 0
buffer_load_dwordx4 v241, s[4:7], s85 offen lds
v_mfma_f32_32x32x16_bf16 v[96:111], v[160:163], a[116:119], v[96:111]
ds_read_b128 v[148:151], v202 offset:31744
s_waitcnt vmcnt(19)
s_waitcnt lgkmcnt(3)
v_mfma_f32_32x32x16_bf16 v[64:79], v[128:131], a[120:123], v[64:79]
ds_read_b128 v[152:155], v200 offset:32768
v_mfma_f32_32x32x16_bf16 v[80:95], v[132:135], a[120:123], v[80:95]
ds_read_b128 v[156:159], v201 offset:32768
s_add_u32 s85, s86, 139264
s_mov_b32 m0, s85
s_nop 0
buffer_load_dwordx4 v241, s[4:7], s85 offen lds
v_mfma_f32_32x32x16_bf16 v[96:111], v[136:139], a[120:123], v[96:111]
ds_read_b128 v[160:163], v202 offset:32768
s_waitcnt vmcnt(19)
s_waitcnt lgkmcnt(3)
v_mfma_f32_32x32x16_bf16 v[64:79], v[140:143], a[124:127], v[64:79]
ds_read_b128 v[128:131], v200 offset:33792
v_mfma_f32_32x32x16_bf16 v[80:95], v[144:147], a[124:127], v[80:95]
ds_read_b128 v[132:135], v201 offset:33792
s_add_u32 s85, s86, 143360
s_mov_b32 m0, s85
s_nop 0
buffer_load_dwordx4 v241, s[4:7], s85 offen lds
v_mfma_f32_32x32x16_bf16 v[96:111], v[148:151], a[124:127], v[96:111]
ds_read_b128 v[136:139], v202 offset:33792
s_waitcnt vmcnt(18)
s_waitcnt lgkmcnt(3)
v_mfma_f32_32x32x16_bf16 v[64:79], v[152:155], a[128:131], v[64:79]
ds_read_b128 v[140:143], v200 offset:34816
v_mfma_f32_32x32x16_bf16 v[80:95], v[156:159], a[128:131], v[80:95]
ds_read_b128 v[144:147], v201 offset:34816
s_add_u32 s85, s86, 147456
s_mov_b32 m0, s85
s_nop 0
buffer_load_dwordx4 v241, s[4:7], s85 offen lds
v_mfma_f32_32x32x16_bf16 v[96:111], v[160:163], a[128:131], v[96:111]
ds_read_b128 v[148:151], v202 offset:34816
s_waitcnt vmcnt(18)
s_waitcnt lgkmcnt(3)
v_mfma_f32_32x32x16_bf16 v[64:79], v[128:131], a[132:135], v[64:79]
ds_read_b128 v[152:155], v200 offset:35840
v_mfma_f32_32x32x16_bf16 v[80:95], v[132:135], a[132:135], v[80:95]
ds_read_b128 v[156:159], v201 offset:35840
s_min_u32 s86, s86, 1024
s_add_u32 s85, s86, 151552
s_mov_b32 m0, s85
s_nop 0
buffer_load_dwordx4 v241, s[4:7], s85 offen lds
v_mfma_f32_32x32x16_bf16 v[96:111], v[136:139], a[132:135], v[96:111]
ds_read_b128 v[160:163], v202 offset:35840
s_waitcnt vmcnt(18)
s_waitcnt lgkmcnt(3)
v_mfma_f32_32x32x16_bf16 v[64:79], v[140:143], a[136:139], v[64:79]
ds_read_b128 v[128:131], v200 offset:36864
v_mfma_f32_32x32x16_bf16 v[80:95], v[144:147], a[136:139], v[80:95]
ds_read_b128 v[132:135], v201 offset:36864
v_mfma_f32_32x32x16_bf16 v[96:111], v[148:151], a[136:139], v[96:111]
ds_read_b128 v[136:139], v202 offset:36864
s_waitcnt vmcnt(11)
v_add_f32 v16, v16, v18
v_add_f32 v17, v17, v19
v_add_f32 v20, v20, v22
v_add_f32 v21, v21, v23
v_add_f32 v16, v16, v20
v_add_f32 v17, v17, v21
s_waitcnt vmcnt(17)
s_waitcnt lgkmcnt(3)
v_mfma_f32_32x32x16_bf16 v[64:79], v[152:155], a[140:143], v[64:79]
ds_read_b128 v[140:143], v200 offset:37888
v_mfma_f32_32x32x16_bf16 v[80:95], v[156:159], a[140:143], v[80:95]
ds_read_b128 v[144:147], v201 offset:37888
s_add_u32 s28, s89, 0
buffer_load_dword v237, v212, s[80:83], s28 offen
v_mfma_f32_32x32x16_bf16 v[96:111], v[160:163], a[140:143], v[96:111]
ds_read_b128 v[148:151], v202 offset:37888
v_mov_b32 v18, v16
s_nop 1
v_permlane32_swap_b32 v16, v18
v_add_f32 v16, v16, v18
v_mov_b32 v19, v17
s_nop 1
v_permlane32_swap_b32 v17, v19
v_add_f32 v17, v17, v19
s_waitcnt vmcnt(17)
s_waitcnt lgkmcnt(3)
v_mfma_f32_32x32x16_bf16 v[64:79], v[128:131], a[144:147], v[64:79]
ds_read_b128 v[152:155], v200 offset:38912
v_mfma_f32_32x32x16_bf16 v[80:95], v[132:135], a[144:147], v[80:95]
ds_read_b128 v[156:159], v201 offset:38912
v_mfma_f32_32x32x16_bf16 v[96:111], v[136:139], a[144:147], v[96:111]
ds_read_b128 v[160:163], v202 offset:38912
v_mul_f32 v16, 0x3acccccd, v16
v_mul_f32 v17, 0x3acccccd, v17
v_fma_f32 v17, -v16, v16, v17
v_max_f32 v17, 0, v17
v_add_f32 v17, 0x3727c5ac, v17
v_rsq_f32 v18, v17
s_waitcnt vmcnt(16)
s_waitcnt lgkmcnt(3)
v_mfma_f32_32x32x16_bf16 v[64:79], v[140:143], a[148:151], v[64:79]
ds_read_b128 v[128:131], v200 offset:39936
v_mfma_f32_32x32x16_bf16 v[80:95], v[144:147], a[148:151], v[80:95]
ds_read_b128 v[132:135], v201 offset:39936
v_mfma_f32_32x32x16_bf16 v[96:111], v[148:151], a[148:151], v[96:111]
ds_read_b128 v[136:139], v202 offset:39936
v_sub_f32 v20, 0, v16
v_mul_f32 v22, 0x3ea52b5c, v18
s_and_b32 s28, s23, 1
s_lshl_b32 s28, s28, 9
s_add_u32 s28, s28, 155648
v_lshlrev_b32 v1, 4, v252
v_add_u32 v1, s28, v1
s_waitcnt vmcnt(11)
s_waitcnt lgkmcnt(3)
v_mfma_f32_32x32x16_bf16 v[64:79], v[152:155], a[152:155], v[64:79]
v_mfma_f32_32x32x16_bf16 v[80:95], v[156:159], a[152:155], v[80:95]
v_mfma_f32_32x32x16_bf16 v[96:111], v[160:163], a[152:155], v[96:111]
ds_read_b128 v[48:51], v1 offset:0
ds_read_b128 v[52:55], v1 offset:32
ds_read_b128 v[56:59], v1 offset:96
ds_read_b128 v[60:63], v1 offset:128
s_waitcnt vmcnt(9)
s_waitcnt lgkmcnt(4)
v_mfma_f32_32x32x16_bf16 v[64:79], v[128:131], a[156:159], v[64:79]
v_mfma_f32_32x32x16_bf16 v[80:95], v[132:135], a[156:159], v[80:95]
s_add_u32 s28, s89, 16384
buffer_load_dword v237, v213, s[80:83], s28 offen
v_mfma_f32_32x32x16_bf16 v[96:111], v[136:139], a[156:159], v[96:111]
s_waitcnt vmcnt(2)
L_gemmend_10:
s_mul_i32 s78, s23, 6291456
s_add_u32 s78, s78, 22020096
s_lshl_b32 s28, s20, 4
s_add_u32 s28, s28, s21
s_mul_i32 s28, s28, 24576
s_add_u32 s28, s28, s78
s_lshl_b32 s29, s22, 9
s_add_u32 s91, s28, s29
v_mov_b32 v34, 0x3f803f80
v_mov_b32 v35, 0
v_mov_b32 v46, 0x3f80
v_mov_b32 v47, 0
s_waitcnt lgkmcnt(3)
v_pk_fma_f32 v[64:65], v[20:21], v[48:49], v[64:65] op_sel_hi:[0,1,1]
v_pk_fma_f32 v[66:67], v[20:21], v[50:51], v[66:67] op_sel_hi:[0,1,1]
v_pk_mul_f32 v[64:65], v[64:65], v[18:19] op_sel_hi:[1,0]
v_pk_mul_f32 v[66:67], v[66:67], v[18:19] op_sel_hi:[1,0]
v_cvt_pk_bf16_f32 v24, v64, v65
v_cvt_pk_bf16_f32 v25, v66, v67
ds_read_b128 v[48:51], v1 offset:64
s_waitcnt lgkmcnt(3)
v_pk_fma_f32 v[68:69], v[20:21], v[52:53], v[68:69] op_sel_hi:[0,1,1]
v_pk_fma_f32 v[70:71], v[20:21], v[54:55], v[70:71] op_sel_hi:[0,1,1]
v_pk_mul_f32 v[68:69], v[68:69], v[18:19] op_sel_hi:[1,0]
v_pk_mul_f32 v[70:71], v[70:71], v[18:19] op_sel_hi:[1,0]
v_cvt_pk_bf16_f32 v26, v68, v69
v_cvt_pk_bf16_f32 v27, v70, v71
ds_read_b128 v[52:55], v1 offset:160
s_add_u32 s29, s91, 0
buffer_store_dwordx4 v[24:27], v209, s[12:15], s29 offen sc1
s_waitcnt lgkmcnt(3)
v_pk_fma_f32 v[76:77], v[20:21], v[56:57], v[76:77] op_sel_hi:[0,1,1]
v_pk_fma_f32 v[78:79], v[20:21], v[58:59], v[78:79] op_sel_hi:[0,1,1]
v_pk_mul_f32 v[76:77], v[76:77], v[18:19] op_sel_hi:[1,0]
v_pk_mul_f32 v[78:79], v[78:79], v[18:19] op_sel_hi:[1,0]
v_cvt_pk_bf16_f32 v28, v76, v77
v_cvt_pk_bf16_f32 v29, v78, v79
ds_read_b128 v[56:59], v1 offset:192
s_waitcnt lgkmcnt(3)
v_pk_fma_f32 v[80:81], v[20:21], v[60:61], v[80:81] op_sel_hi:[0,1,1]
v_pk_fma_f32 v[82:83], v[20:21], v[62:63], v[82:83] op_sel_hi:[0,1,1]
v_pk_mul_f32 v[80:81], v[80:81], v[18:19] op_sel_hi:[1,0]
v_pk_mul_f32 v[82:83], v[82:83], v[18:19] op_sel_hi:[1,0]
v_cvt_pk_bf16_f32 v30, v80, v81
v_cvt_pk_bf16_f32 v31, v82, v83
ds_read_b128 v[60:63], v1 offset:256
s_add_u32 s29, s91, 4096
buffer_store_dwordx4 v[28:31], v209, s[12:15], s29 offen sc1
s_waitcnt lgkmcnt(3)
v_pk_fma_f32 v[72:73], v[20:21], v[48:49], v[72:73] op_sel_hi:[0,1,1]
v_pk_fma_f32 v[74:75], v[20:21], v[50:51], v[74:75] op_sel_hi:[0,1,1]
v_pk_mul_f32 v[72:73], v[72:73], v[18:19] op_sel_hi:[1,0]
v_pk_mul_f32 v[74:75], v[74:75], v[18:19] op_sel_hi:[1,0]
v_cvt_pk_bf16_f32 v32, v72, v73
v_cvt_pk_bf16_f32 v33, v74, v75
ds_read_b128 v[48:51], v1 offset:288
s_add_u32 s29, s91, 8192
buffer_store_dwordx4 v[32:35], v209, s[12:15], s29 offen sc1
s_waitcnt lgkmcnt(3)
v_pk_fma_f32 v[84:85], v[20:21], v[52:53], v[84:85] op_sel_hi:[0,1,1]
v_pk_fma_f32 v[86:87], v[20:21], v[54:55], v[86:87] op_sel_hi:[0,1,1]
v_pk_mul_f32 v[84:85], v[84:85], v[18:19] op_sel_hi:[1,0]
v_pk_mul_f32 v[86:87], v[86:87], v[18:19] op_sel_hi:[1,0]
v_cvt_pk_bf16_f32 v36, v84, v85
v_cvt_pk_bf16_f32 v37, v86, v87
ds_read_b128 v[52:55], v1 offset:224
s_waitcnt lgkmcnt(3)
v_pk_fma_f32 v[88:89], v[20:21], v[56:57], v[88:89] op_sel_hi:[0,1,1]
v_pk_fma_f32 v[90:91], v[20:21], v[58:59], v[90:91] op_sel_hi:[0,1,1]
v_pk_mul_f32 v[88:89], v[88:89], v[18:19] op_sel_hi:[1,0]
v_pk_mul_f32 v[90:91], v[90:91], v[18:19] op_sel_hi:[1,0]
v_cvt_pk_bf16_f32 v38, v88, v89
v_cvt_pk_bf16_f32 v39, v90, v91
ds_read_b128 v[56:59], v1 offset:320
s_add_u32 s29, s91, 12288
buffer_store_dwordx4 v[36:39], v209, s[12:15], s29 offen sc1
s_waitcnt lgkmcnt(3)
v_pk_fma_f32 v[96:97], v[20:21], v[60:61], v[96:97] op_sel_hi:[0,1,1]
v_pk_fma_f32 v[98:99], v[20:21], v[62:63], v[98:99] op_sel_hi:[0,1,1]
v_pk_mul_f32 v[96:97], v[96:97], v[18:19] op_sel_hi:[1,0]
v_pk_mul_f32 v[98:99], v[98:99], v[18:19] op_sel_hi:[1,0]
v_cvt_pk_bf16_f32 v40, v96, v97
v_cvt_pk_bf16_f32 v41, v98, v99
ds_read_b128 v[60:63], v1 offset:352
s_waitcnt lgkmcnt(3)
v_pk_fma_f32 v[100:101], v[20:21], v[48:49], v[100:101] op_sel_hi:[0,1,1]
v_pk_fma_f32 v[102:103], v[20:21], v[50:51], v[102:103] op_sel_hi:[0,1,1]
v_pk_mul_f32 v[100:101], v[100:101], v[18:19] op_sel_hi:[1,0]
v_pk_mul_f32 v[102:103], v[102:103], v[18:19] op_sel_hi:[1,0]
v_cvt_pk_bf16_f32 v42, v100, v101
v_cvt_pk_bf16_f32 v43, v102, v103
s_add_u32 s29, s91, 18432
buffer_store_dwordx4 v[40:43], v209, s[12:15], s29 offen sc1
s_waitcnt lgkmcnt(2)
v_pk_fma_f32 v[92:93], v[20:21], v[52:53], v[92:93] op_sel_hi:[0,1,1]
v_pk_fma_f32 v[94:95], v[20:21], v[54:55], v[94:95] op_sel_hi:[0,1,1]
v_pk_mul_f32 v[92:93], v[92:93], v[18:19] op_sel_hi:[1,0]
v_pk_mul_f32 v[94:95], v[94:95], v[18:19] op_sel_hi:[1,0]
v_cvt_pk_bf16_f32 v44, v92, v93
v_cvt_pk_bf16_f32 v45, v94, v95
s_add_u32 s29, s91, 12288
buffer_store_dwordx4 v[44:47], v210, s[12:15], s29 offen sc1
s_barrier
ds_read_b128 v[128:131], v203 offset:0
ds_read_b128 v[132:135], v203 offset:768
ds_read_b128 v[136:139], v203 offset:1536
ds_read_b128 v[140:143], v203 offset:2304
ds_read_b128 v[144:147], v203 offset:3072
s_waitcnt lgkmcnt(4)
v_mfma_f32_32x32x16_bf16 v[112:127], v[128:131], a[0:3], 0
ds_read_b128 v[148:151], v203 offset:3840
s_waitcnt lgkmcnt(4)
v_mfma_f32_32x32x16_bf16 v[112:127], v[132:135], a[4:7], v[112:127]
ds_read_b128 v[128:131], v203 offset:4608
ds_write_b128 v206, v[24:27] offset:0
s_waitcnt lgkmcnt(5)
v_mfma_f32_32x32x16_bf16 v[112:127], v[136:139], a[8:11], v[112:127]
ds_read_b128 v[132:135], v203 offset:5376
ds_write_b128 v206, v[28:31] offset:12288
s_waitcnt lgkmcnt(6)
v_mfma_f32_32x32x16_bf16 v[112:127], v[140:143], a[12:15], v[112:127]
ds_read_b128 v[136:139], v203 offset:6144
ds_write_b128 v206, v[32:35] offset:24576
s_waitcnt lgkmcnt(7)
v_mfma_f32_32x32x16_bf16 v[112:127], v[144:147], a[16:19], v[112:127]
ds_read_b128 v[140:143], v203 offset:6912
ds_write_b128 v207, v[36:39] offset:0
s_add_u32 s28, s89, 32768
buffer_load_dword v237, v214, s[80:83], s28 offen
s_waitcnt lgkmcnt(8)
v_mfma_f32_32x32x16_bf16 v[112:127], v[148:151], a[20:23], v[112:127]
ds_read_b128 v[144:147], v203 offset:7680
ds_write_b128 v207, v[40:43] offset:18624
s_waitcnt lgkmcnt(9)
v_mfma_f32_32x32x16_bf16 v[112:127], v[128:131], a[24:27], v[112:127]
ds_read_b128 v[148:151], v203 offset:8448
ds_write_b128 v208, v[44:47] offset:0
s_waitcnt lgkmcnt(9)
v_mfma_f32_32x32x16_bf16 v[112:127], v[132:135], a[28:31], v[112:127]
ds_read_b128 v[128:131], v203 offset:9216
s_waitcnt lgkmcnt(8)
v_mfma_f32_32x32x16_bf16 v[112:127], v[136:139], a[32:35], v[112:127]
ds_read_b128 v[132:135], v203 offset:9984
s_waitcnt lgkmcnt(7)
v_mfma_f32_32x32x16_bf16 v[112:127], v[140:143], a[36:39], v[112:127]
ds_read_b128 v[136:139], v203 offset:10752
s_waitcnt lgkmcnt(15)
v_pk_fma_f32 v[104:105], v[20:21], v[56:57], v[104:105] op_sel_hi:[0,1,1]
v_pk_fma_f32 v[106:107], v[20:21], v[58:59], v[106:107] op_sel_hi:[0,1,1]
v_pk_mul_f32 v[104:105], v[104:105], v[22:23] op_sel_hi:[1,0]
v_pk_mul_f32 v[106:107], v[106:107], v[22:23] op_sel_hi:[1,0]
v_cvt_pk_bf16_f32 v152, v104, v105
v_cvt_pk_bf16_f32 v153, v106, v107
s_waitcnt lgkmcnt(6)
v_mfma_f32_32x32x16_bf16 v[112:127], v[144:147], a[40:43], v[112:127]
ds_read_b128 v[140:143], v203 offset:11520
s_waitcnt lgkmcnt(5)
v_mfma_f32_32x32x16_bf16 v[112:127], v[148:151], a[44:47], v[112:127]
ds_read_b128 v[144:147], v203 offset:12288
s_waitcnt lgkmcnt(4)
v_mfma_f32_32x32x16_bf16 v[112:127], v[128:131], a[48:51], v[112:127]
ds_read_b128 v[148:151], v203 offset:13056
s_waitcnt lgkmcnt(15)
v_pk_fma_f32 v[108:109], v[20:21], v[60:61], v[108:109] op_sel_hi:[0,1,1]
v_pk_fma_f32 v[110:111], v[20:21], v[62:63], v[110:111] op_sel_hi:[0,1,1]
v_pk_mul_f32 v[108:109], v[108:109], v[22:23] op_sel_hi:[1,0]
v_pk_mul_f32 v[110:111], v[110:111], v[22:23] op_sel_hi:[1,0]
v_cvt_pk_bf16_f32 v154, v108, v109
v_cvt_pk_bf16_f32 v155, v110, v111
s_waitcnt lgkmcnt(4)
v_mfma_f32_32x32x16_bf16 v[112:127], v[132:135], a[52:55], v[112:127]
ds_read_b128 v[128:131], v203 offset:13824
s_waitcnt lgkmcnt(4)
v_mfma_f32_32x32x16_bf16 v[112:127], v[136:139], a[56:59], v[112:127]
ds_read_b128 v[132:135], v203 offset:14592
s_waitcnt lgkmcnt(4)
v_mfma_f32_32x32x16_bf16 v[112:127], v[140:143], a[60:63], v[112:127]
ds_read_b128 v[136:139], v203 offset:15360
s_waitcnt lgkmcnt(4)
v_mfma_f32_32x32x16_bf16 v[112:127], v[144:147], a[64:67], v[112:127]
ds_read_b128 v[140:143], v203 offset:16128
s_waitcnt lgkmcnt(4)
v_mfma_f32_32x32x16_bf16 v[112:127], v[148:151], a[68:71], v[112:127]
ds_read_b128 v[144:147], v203 offset:16896
s_waitcnt lgkmcnt(4)
v_mfma_f32_32x32x16_bf16 v[112:127], v[128:131], a[72:75], v[112:127]
ds_read_b128 v[148:151], v203 offset:17664
s_waitcnt lgkmcnt(4)
v_mfma_f32_32x32x16_bf16 v[112:127], v[132:135], a[76:79], v[112:127]
ds_read_b128 v[128:131], v203 offset:18432
s_waitcnt lgkmcnt(4)
v_mfma_f32_32x32x16_bf16 v[112:127], v[136:139], a[80:83], v[112:127]
ds_read_b128 v[132:135], v203 offset:19200
s_waitcnt lgkmcnt(4)
v_mfma_f32_32x32x16_bf16 v[112:127], v[140:143], a[84:87], v[112:127]
ds_read_b128 v[136:139], v203 offset:19968
s_waitcnt lgkmcnt(4)
v_mfma_f32_32x32x16_bf16 v[112:127], v[144:147], a[88:91], v[112:127]
ds_read_b128 v[140:143], v203 offset:20736
s_waitcnt lgkmcnt(4)
v_mfma_f32_32x32x16_bf16 v[112:127], v[148:151], a[92:95], v[112:127]
ds_read_b128 v[144:147], v203 offset:21504
s_waitcnt lgkmcnt(4)
v_mfma_f32_32x32x16_bf16 v[112:127], v[128:131], a[96:99], v[112:127]
ds_read_b128 v[148:151], v203 offset:22272
s_waitcnt lgkmcnt(4)
v_mfma_f32_32x32x16_bf16 v[112:127], v[132:135], a[100:103], v[112:127]
ds_read_b128 v[128:131], v203 offset:23040
s_waitcnt lgkmcnt(4)
v_mfma_f32_32x32x16_bf16 v[112:127], v[136:139], a[104:107], v[112:127]
ds_read_b128 v[132:135], v203 offset:23808
s_waitcnt lgkmcnt(4)
v_mfma_f32_32x32x16_bf16 v[112:127], v[140:143], a[108:111], v[112:127]
ds_read_b128 v[136:139], v203 offset:24576
s_waitcnt lgkmcnt(4)
v_mfma_f32_32x32x16_bf16 v[112:127], v[144:147], a[112:115], v[112:127]
ds_read_b128 v[140:143], v203 offset:25344
s_waitcnt vmcnt(1)
s_add_u32 s24, s23, 2
s_add_u32 s24, s26, s24
s_addc_u32 s25, s27, 0
s_lshl_b32 s28, s20, 4
s_add_u32 s28, s28, s21
s_lshl_b32 s28, s28, 7
s_lshl_b32 s29, s22, 3
s_add_u32 s28, s28, s29
s_add_u32 s28, s28, 32768
v_mov_b32 v6, s28
v_mov_b32 v8, s24
v_mov_b32 v9, s25
s_mov_b64 s[62:63], exec
s_mov_b64 exec, 1
buffer_store_dwordx2 v[8:9], v6, s[12:15], 0 offen sc1
s_mov_b64 exec, s[62:63]
s_waitcnt lgkmcnt(4)
s_nop 2
v_mfma_f32_32x32x16_bf16 v[112:127], v[148:151], a[116:119], v[112:127]
ds_read_b128 v[144:147], v203 offset:26112
s_waitcnt lgkmcnt(4)
v_mfma_f32_32x32x16_bf16 v[112:127], v[128:131], a[120:123], v[112:127]
ds_read_b128 v[148:151], v203 offset:26880
ds_read_b128 v[48:51], v1 offset:384
ds_read_b128 v[52:55], v1 offset:416
ds_read_b128 v[56:59], v1 offset:448
s_waitcnt lgkmcnt(7)
v_mfma_f32_32x32x16_bf16 v[112:127], v[132:135], a[124:127], v[112:127]
ds_read_b128 v[128:131], v203 offset:27648
s_waitcnt lgkmcnt(7)
v_mfma_f32_32x32x16_bf16 v[112:127], v[136:139], a[128:131], v[112:127]
ds_read_b128 v[132:135], v203 offset:28416
s_waitcnt lgkmcnt(7)
v_mfma_f32_32x32x16_bf16 v[112:127], v[140:143], a[132:135], v[112:127]
ds_read_b128 v[136:139], v203 offset:29184
s_waitcnt lgkmcnt(7)
v_mfma_f32_32x32x16_bf16 v[112:127], v[144:147], a[136:139], v[112:127]
ds_read_b128 v[140:143], v203 offset:29952
s_waitcnt lgkmcnt(7)
v_mfma_f32_32x32x16_bf16 v[112:127], v[148:151], a[140:143], v[112:127]
s_waitcnt lgkmcnt(3)
v_mfma_f32_32x32x16_bf16 v[112:127], v[128:131], a[144:147], v[112:127]
s_add_u32 s28, s89, 49152
buffer_load_dword v237, v215, s[80:83], s28 offen
s_waitcnt lgkmcnt(2)
v_mfma_f32_32x32x16_bf16 v[112:127], v[132:135], a[148:151], v[112:127]
s_waitcnt lgkmcnt(1)
v_mfma_f32_32x32x16_bf16 v[112:127], v[136:139], a[152:155], v[112:127]
s_waitcnt lgkmcnt(0)
v_mfma_f32_32x32x16_bf16 v[112:127], v[140:143], a[156:159], v[112:127]
s_waitcnt lgkmcnt(6)
s_nop 10
v_pk_fma_f32 v[112:113], v[20:21], v[48:49], v[112:113] op_sel_hi:[0,1,1]
v_pk_fma_f32 v[114:115], v[20:21], v[50:51], v[114:115] op_sel_hi:[0,1,1]
v_pk_mul_f32 v[112:113], v[112:113], v[22:23] op_sel_hi:[1,0]
v_pk_mul_f32 v[114:115], v[114:115], v[22:23] op_sel_hi:[1,0]
v_cvt_pk_bf16_f32 v160, v112, v113
v_cvt_pk_bf16_f32 v161, v114, v115
s_waitcnt lgkmcnt(5)
v_pk_fma_f32 v[116:117], v[20:21], v[52:53], v[116:117] op_sel_hi:[0,1,1]
v_pk_fma_f32 v[118:119], v[20:21], v[54:55], v[118:119] op_sel_hi:[0,1,1]
v_pk_mul_f32 v[116:117], v[116:117], v[22:23] op_sel_hi:[1,0]
v_pk_mul_f32 v[118:119], v[118:119], v[22:23] op_sel_hi:[1,0]
v_cvt_pk_bf16_f32 v156, v116, v117
v_cvt_pk_bf16_f32 v157, v118, v119
s_waitcnt lgkmcnt(4)
v_pk_fma_f32 v[120:121], v[20:21], v[56:57], v[120:121] op_sel_hi:[0,1,1]
v_pk_fma_f32 v[122:123], v[20:21], v[58:59], v[122:123] op_sel_hi:[0,1,1]
v_pk_mul_f32 v[120:121], v[120:121], v[22:23] op_sel_hi:[1,0]
v_pk_mul_f32 v[122:123], v[122:123], v[22:23] op_sel_hi:[1,0]
v_cvt_pk_bf16_f32 v158, v120, v121
v_cvt_pk_bf16_f32 v159, v122, v123
v_cndmask_b32 v140, 0, v160, s[68:69]
v_cndmask_b32 v141, 0, v161, s[68:69]
v_cndmask_b32 v136, 0, v160, s[66:67]
v_cndmask_b32 v137, 0, v161, s[66:67]
v_mov_b32 v128, v152
v_mov_b32 v129, v153
v_mov_b32 v130, v154
v_mov_b32 v131, v155
v_mov_b32 v132, v156
v_mov_b32 v133, v157
v_mov_b32 v134, v158
v_mov_b32 v135, v159
v_mov_b32 v2, 0x3f80
v_mov_b32 v138, 0
v_cndmask_b32 v139, 0, v2, s[66:67]
v_mov_b32 v142, 0
v_cndmask_b32 v143, 0, v2, s[68:69]
s_bitcmp1_b32 s23, 0
s_cbranch_scc0 L_attnA
s_lshl_b32 s28, s20, 4
s_add_u32 s28, s28, s21
s_lshl_b32 s28, s28, 7
s_add_u32 s28, s28, 32768
v_lshrrev_b32 v7, 2, v0
v_add_u32 v7, 1, v7
v_lshlrev_b32 v7, 11, v7
v_sub_u32 v216, s28, v7
v_and_b32 v7, 3, v0
v_lshlrev_b32 v7, 3, v7
v_add_u32 v216, v216, v7
s_cmp_lg_u32 s22, 0
s_cbranch_scc1 L_epoll_11
s_mov_b64 s[62:63], exec
s_mov_b64 exec, 0xff
buffer_load_dwordx2 v[218:219], v216, s[12:15], 0 offen sc1
s_mov_b64 exec, s[62:63]
L_epoll_11:
v_accvgpr_read_b32 v144, a192
v_accvgpr_read_b32 v145, a193
v_accvgpr_read_b32 v146, a194
v_accvgpr_read_b32 v147, a195
v_accvgpr_read_b32 v148, a196
v_accvgpr_read_b32 v149, a197
v_accvgpr_read_b32 v150, a198
v_accvgpr_read_b32 v151, a199
v_accvgpr_read_b32 v152, a200
v_accvgpr_read_b32 v153, a201
v_accvgpr_read_b32 v154, a202
v_accvgpr_read_b32 v155, a203
v_accvgpr_read_b32 v156, a204
v_accvgpr_read_b32 v157, a205
v_accvgpr_read_b32 v158, a206
v_accvgpr_read_b32 v159, a207
v_accvgpr_read_b32 v160, a208
v_accvgpr_read_b32 v161, a209
v_accvgpr_read_b32 v162, a210
v_accvgpr_read_b32 v163, a211
v_accvgpr_read_b32 v164, a212
v_accvgpr_read_b32 v165, a213
v_accvgpr_read_b32 v166, a214
v_accvgpr_read_b32 v167, a215
v_accvgpr_read_b32 v168, a216
v_accvgpr_read_b32 v169, a217
v_accvgpr_read_b32 v170, a218
v_accvgpr_read_b32 v171, a219
v_accvgpr_read_b32 v172, a220
v_accvgpr_read_b32 v173, a221
v_accvgpr_read_b32 v174, a222
v_accvgpr_read_b32 v175, a223
s_waitcnt lgkmcnt(0)
s_barrier
s_cmp_eq_u32 s22, 0
s_cbranch_scc1 L_kvw0_13
s_branch L_kvaj_14
L_kvw0_13:
L_kvaj_14:
v_mov_b32 v3, v196
v_mov_b32 v4, v197
v_mov_b32 v5, v198
v_mov_b32 v9, v199
v_mov_b32 v10, v211
v_mov_b32 v15, v224
s_mul_i32 s79, s23, 0
s_add_u32 s79, s79, 11534336
s_lshl_b32 s28, s20, 3
s_lshl_b32 s29, s22, 1
s_add_u32 s28, s28, s29
s_mul_i32 s28, s28, 20480
s_add_u32 s79, s79, s28
s_mul_i32 s28, s21, 1280
s_add_u32 s79, s79, s28
s_lshl_b32 s28, s20, 3
s_mul_i32 s28, s28, 20480
s_mul_i32 s29, s21, 1280
s_add_u32 s28, s28, s29
s_add_u32 s90, s28, 11534336
v_mov_b32 v138, 0
v_mov_b32 v142, 0
ds_read_b128 a[40:43], v3 offset:4096
ds_read_b128 a[44:47], v4 offset:4096
ds_read_b128 a[48:51], v3 offset:16384
ds_read_b128 a[52:55], v4 offset:10240
s_waitcnt lgkmcnt(2)
v_mfma_f32_32x32x16_bf16 v[16:31], a[40:43], v[128:131], v[144:159]
v_mfma_f32_32x32x16_bf16 v[16:31], a[44:47], v[136:139], v[16:31]
s_waitcnt lgkmcnt(0)
v_mfma_f32_32x32x16_bf16 v[32:47], a[48:51], v[132:135], v[144:159]
v_mfma_f32_32x32x16_bf16 v[32:47], a[52:55], v[140:143], v[32:47]
v_mov_b32 v11, 0xff7fffff
v_mov_b32 v14, 0xff7fffff
s_nop 6
v_max3_f32 v11, v11, v16, v17
v_max3_f32 v11, v11, v18, v19
v_max3_f32 v11, v11, v20, v21
v_max3_f32 v11, v11, v22, v23
v_max3_f32 v11, v11, v24, v25
v_max3_f32 v11, v11, v26, v27
v_max3_f32 v11, v11, v28, v29
v_max3_f32 v11, v11, v30, v31
v_max3_f32 v14, v14, v32, v33
v_max3_f32 v14, v14, v34, v35
v_max3_f32 v14, v14, v36, v37
v_max3_f32 v14, v14, v38, v39
v_max3_f32 v14, v14, v40, v41
v_max3_f32 v14, v14, v42, v43
v_max3_f32 v14, v14, v44, v45
v_max3_f32 v14, v14, v46, v47
v_mov_b32 v12, v11
s_nop 1
v_permlane32_swap_b32 v11, v12
v_max_f32 v11, v11, v12
v_and_b32 v12, 0xffff0000, v11
v_sub_f32 v13, v11, v12
v_cvt_pk_bf16_f32 v12, -v12, -v13
v_lshlrev_b32 v13, 16, v12
v_and_b32 v6, 0xffff0000, v12
v_add_f32 v6, v6, v13
v_cndmask_b32 v138, 0, v12, s[66:67]
v_mov_b32 v12, v14
s_nop 1
v_permlane32_swap_b32 v14, v12
v_max_f32 v14, v14, v12
v_and_b32 v12, 0xffff0000, v14
v_sub_f32 v13, v14, v12
v_cvt_pk_bf16_f32 v12, -v12, -v13
v_lshlrev_b32 v13, 16, v12
v_and_b32 v8, 0xffff0000, v12
v_add_f32 v8, v8, v13
v_cndmask_b32 v142, 0, v12, s[68:69]
s_mov_b32 s38, 0
s_cmp_lg_u32 s22, 0
s_cbranch_scc1 L_kvskip2_15
s_add_u32 s24, s23, 2
s_add_u32 s24, s26, s24
s_addc_u32 s25, s27, 0
s_mov_b64 s[62:63], exec
s_min_u32 s29, s20, 2
s_cmp_eq_u32 s29, 0
s_cbranch_scc1 L_kvnp_16
s_lshl_b32 s29, s29, 2
s_lshl_b32 s30, 1, s29
s_sub_u32 s30, s30, 1
s_mov_b32 s31, 0
s_mov_b64 exec, s[30:31]
s_waitcnt vmcnt(0)
v_cmp_ne_u64 vcc, s[24:25], v[218:219]
s_cmp_eq_u64 vcc, 0
s_cbranch_scc1 L_kvnp_16
s_mov_b32 s39, 524288
L_poll_17:
buffer_load_dwordx2 v[218:219], v216, s[12:15], 0 offen sc1
s_waitcnt vmcnt(0)
v_cmp_ne_u64 vcc, s[24:25], v[218:219]
s_cmp_eq_u64 vcc, 0
s_cbranch_scc1 L_pdone_18
s_sub_u32 s39, s39, 1
s_cmp_lg_u32 s39, 0
s_cbranch_scc1 L_poll_17
L_pdone_18:
L_kvnp_16:
s_mov_b64 exec, s[62:63]
L_kvskip2_15:
s_barrier
s_lshr_b32 s30, s22, 1
s_add_u32 s31, s30, 1
s_and_b32 s29, s22, 1
s_lshl_b32 s33, s29, 10
s_xor_b32 s30, s30, 1
s_lshl_b32 s30, s30, 11
s_add_u32 s34, s30, s33
s_cmp_lt_u32 s20, s31
s_cbranch_scc1 L_fill_19
s_sub_u32 s28, s20, s31
s_lshl_b32 s28, s28, 4
s_add_u32 s28, s28, s21
s_mul_i32 s28, s28, 24576
s_add_u32 s28, s28, s78
s_add_u32 s28, s28, s33
s_add_u32 m0, s34, 0
s_add_u32 s29, s28, 0
buffer_load_dwordx4 v241, s[12:15], s29 offen sc1 lds
s_add_u32 m0, s34, 6144
s_add_u32 s29, s28, 2048
buffer_load_dwordx4 v241, s[12:15], s29 offen sc1 lds
s_add_u32 m0, s34, 24576
s_add_u32 s29, s28, 8192
buffer_load_dwordx4 v241, s[12:15], s29 offen sc1 lds
s_add_u32 m0, s34, 36864
s_add_u32 s29, s28, 12288
buffer_load_dwordx4 v241, s[12:15], s29 offen sc1 lds
s_add_u32 m0, s34, 43072
s_add_u32 s29, s28, 14336
buffer_load_dwordx4 v241, s[12:15], s29 offen sc1 lds
s_add_u32 m0, s34, 49280
s_add_u32 s29, s28, 16384
buffer_load_dwordx4 v241, s[12:15], s29 offen sc1 lds
s_add_u32 m0, s34, 12288
s_add_u32 s29, s28, 4096
buffer_load_dwordx4 v241, s[12:15], s29 offen sc1 lds
s_add_u32 m0, s34, 18432
s_add_u32 s29, s28, 6144
buffer_load_dwordx4 v241, s[12:15], s29 offen sc1 lds
s_add_u32 m0, s34, 30720
s_add_u32 s29, s28, 10240
buffer_load_dwordx4 v241, s[12:15], s29 offen sc1 lds
s_add_u32 m0, s34, 55488
s_add_u32 s29, s28, 18432
buffer_load_dwordx4 v241, s[12:15], s29 offen sc1 lds
s_add_u32 m0, s34, 61696
s_add_u32 s29, s28, 20480
buffer_load_dwordx4 v241, s[12:15], s29 offen sc1 lds
s_add_u32 m0, s34, 67904
s_add_u32 s29, s28, 22528
buffer_load_dwordx4 v241, s[12:15], s29 offen sc1 lds
s_branch L_fend_20
L_fill_19:
v_mov_b32 v220, 0
v_mov_b32 v221, 0
v_mov_b32 v222, 0
v_mov_b32 v223, 0
v_add_u32 v216, s34, v241
v_add_u32 v217, 36864, v216
ds_write_b128 v216, v[220:223] offset:0
ds_write_b128 v216, v[220:223] offset:6144
ds_write_b128 v216, v[220:223] offset:12288
ds_write_b128 v216, v[220:223] offset:18432
v_mov_b32 v223, 0xF149
ds_write_b128 v216, v[220:223] offset:24576
v_mov_b32 v223, 0
v_mov_b32 v223, 0xF149
ds_write_b128 v216, v[220:223] offset:30720
v_mov_b32 v223, 0
ds_write_b128 v217, v[220:223] offset:0
ds_write_b128 v217, v[220:223] offset:6208
ds_write_b128 v217, v[220:223] offset:12416
ds_write_b128 v217, v[220:223] offset:18624
ds_write_b128 v217, v[220:223] offset:24832
ds_write_b128 v217, v[220:223] offset:31040
L_fend_20:
L_pass2_21:
ds_read_b64_tr_b16 a[24:25], v5 offset:4096
ds_read_b64_tr_b16 a[26:27], v5 offset:4224
ds_read_b64_tr_b16 a[28:29], v5 offset:4352
ds_read_b64_tr_b16 a[30:31], v5 offset:4480
ds_read_b64_tr_b16 a[32:33], v5 offset:22720
ds_read_b64_tr_b16 a[34:35], v5 offset:22848
ds_read_b64_tr_b16 a[36:37], v5 offset:22976
ds_read_b64_tr_b16 a[38:39], v5 offset:23104
v_pk_add_f32 v[16:17], v[16:17], v[6:7] op_sel_hi:[1,0]
v_pk_add_f32 v[18:19], v[18:19], v[6:7] op_sel_hi:[1,0]
v_pk_add_f32 v[20:21], v[20:21], v[6:7] op_sel_hi:[1,0]
v_pk_add_f32 v[22:23], v[22:23], v[6:7] op_sel_hi:[1,0]
v_pk_add_f32 v[24:25], v[24:25], v[6:7] op_sel_hi:[1,0]
v_pk_add_f32 v[26:27], v[26:27], v[6:7] op_sel_hi:[1,0]
v_pk_add_f32 v[28:29], v[28:29], v[6:7] op_sel_hi:[1,0]
v_pk_add_f32 v[30:31], v[30:31], v[6:7] op_sel_hi:[1,0]
v_exp_f32 v16, v16
v_exp_f32 v17, v17
v_exp_f32 v18, v18
v_exp_f32 v19, v19
v_exp_f32 v20, v20
v_exp_f32 v21, v21
v_exp_f32 v22, v22
v_exp_f32 v23, v23
v_exp_f32 v24, v24
v_exp_f32 v25, v25
v_exp_f32 v26, v26
v_exp_f32 v27, v27
v_exp_f32 v28, v28
v_exp_f32 v29, v29
v_exp_f32 v30, v30
v_exp_f32 v31, v31
v_cvt_pk_bf16_f32 v80, v16, v17
v_cvt_pk_bf16_f32 v81, v18, v19
v_cvt_pk_bf16_f32 v82, v20, v21
v_cvt_pk_bf16_f32 v83, v22, v23
v_cvt_pk_bf16_f32 v84, v24, v25
v_cvt_pk_bf16_f32 v85, v26, v27
v_cvt_pk_bf16_f32 v86, v28, v29
v_cvt_pk_bf16_f32 v87, v30, v31
s_waitcnt lgkmcnt(4)
v_mfma_f32_32x32x16_bf16 v[64:79], a[24:27], v[80:83], 0
v_mfma_f32_32x32x16_bf16 v[64:79], a[28:31], v[84:87], v[64:79]
v_pk_add_f32 v[32:33], v[32:33], v[8:9] op_sel_hi:[1,0]
v_pk_add_f32 v[34:35], v[34:35], v[8:9] op_sel_hi:[1,0]
v_pk_add_f32 v[36:37], v[36:37], v[8:9] op_sel_hi:[1,0]
v_pk_add_f32 v[38:39], v[38:39], v[8:9] op_sel_hi:[1,0]
v_pk_add_f32 v[40:41], v[40:41], v[8:9] op_sel_hi:[1,0]
v_pk_add_f32 v[42:43], v[42:43], v[8:9] op_sel_hi:[1,0]
v_pk_add_f32 v[44:45], v[44:45], v[8:9] op_sel_hi:[1,0]
v_pk_add_f32 v[46:47], v[46:47], v[8:9] op_sel_hi:[1,0]
v_exp_f32 v32, v32
v_exp_f32 v33, v33
v_exp_f32 v34, v34
v_exp_f32 v35, v35
v_exp_f32 v36, v36
v_exp_f32 v37, v37
v_exp_f32 v38, v38
v_exp_f32 v39, v39
v_exp_f32 v40, v40
v_exp_f32 v41, v41
v_exp_f32 v42, v42
v_exp_f32 v43, v43
v_exp_f32 v44, v44
v_exp_f32 v45, v45
v_exp_f32 v46, v46
v_exp_f32 v47, v47
v_cvt_pk_bf16_f32 v88, v32, v33
v_cvt_pk_bf16_f32 v89, v34, v35
v_cvt_pk_bf16_f32 v90, v36, v37
v_cvt_pk_bf16_f32 v91, v38, v39
v_cvt_pk_bf16_f32 v92, v40, v41
v_cvt_pk_bf16_f32 v93, v42, v43
v_cvt_pk_bf16_f32 v94, v44, v45
v_cvt_pk_bf16_f32 v95, v46, v47
s_waitcnt lgkmcnt(0)
v_mfma_f32_32x32x16_bf16 v[96:111], a[32:35], v[88:91], 0
v_mfma_f32_32x32x16_bf16 v[96:111], a[36:39], v[92:95], v[96:111]
s_cmp_lg_u32 s38, 0
s_cbranch_scc1 L_skipkv_22
s_waitcnt vmcnt(9)
s_waitcnt lgkmcnt(0)
s_barrier
L_skipkv_22:
ds_read_b128 a[0:3], v3 offset:0
ds_read_b128 a[4:7], v4 offset:0
ds_read_b128 a[8:11], v3 offset:512
ds_read_b128 a[12:15], v4 offset:512
ds_read_b128 a[16:19], v3 offset:1024
ds_read_b128 a[20:23], v4 offset:1024
s_waitcnt lgkmcnt(4)
v_mfma_f32_32x32x16_bf16 v[16:31], a[0:3], v[128:131], v[160:175]
v_mfma_f32_32x32x16_bf16 v[16:31], a[4:7], v[136:139], v[16:31]
s_waitcnt lgkmcnt(2)
v_mfma_f32_32x32x16_bf16 v[32:47], a[8:11], v[128:131], 0
v_mfma_f32_32x32x16_bf16 v[32:47], a[12:15], v[136:139], v[32:47]
s_cmp_lg_u32 s38, 0
s_cbranch_scc1 L_sbar_23
s_waitcnt vmcnt(6)
s_barrier
L_sbar_23:
ds_read_b64_tr_b16 a[24:25], v5 offset:0
ds_read_b64_tr_b16 a[26:27], v5 offset:128
ds_read_b64_tr_b16 a[28:29], v5 offset:256
ds_read_b64_tr_b16 a[30:31], v5 offset:384
s_nop 2
v_exp_f32 v16, v16
v_exp_f32 v17, v17
v_exp_f32 v18, v18
v_exp_f32 v19, v19
v_exp_f32 v20, v20
v_exp_f32 v21, v21
v_exp_f32 v22, v22
v_exp_f32 v23, v23
s_waitcnt lgkmcnt(4)
v_mfma_f32_32x32x16_bf16 v[48:63], a[16:19], v[128:131], 0
v_exp_f32 v24, v24
v_exp_f32 v25, v25
v_exp_f32 v26, v26
v_exp_f32 v27, v27
v_mfma_f32_32x32x16_bf16 v[48:63], a[20:23], v[136:139], v[48:63]
v_exp_f32 v28, v28
v_exp_f32 v29, v29
v_exp_f32 v30, v30
v_exp_f32 v31, v31
ds_read_b128 a[0:3], v3 offset:1536
ds_read_b128 a[4:7], v4 offset:1536
ds_read_b64_tr_b16 a[32:33], v5 offset:512
ds_read_b64_tr_b16 a[34:35], v5 offset:640
ds_read_b64_tr_b16 a[36:37], v5 offset:768
ds_read_b64_tr_b16 a[38:39], v5 offset:896
v_cvt_pk_bf16_f32 v80, v16, v17
v_cvt_pk_bf16_f32 v81, v18, v19
v_cvt_pk_bf16_f32 v82, v20, v21
v_cvt_pk_bf16_f32 v83, v22, v23
v_cvt_pk_bf16_f32 v84, v24, v25
v_cvt_pk_bf16_f32 v85, v26, v27
v_cvt_pk_bf16_f32 v86, v28, v29
v_cvt_pk_bf16_f32 v87, v30, v31
s_waitcnt lgkmcnt(6)
v_mfma_f32_32x32x16_bf16 v[64:79], a[24:27], v[80:83], v[64:79]
v_exp_f32 v32, v32
v_exp_f32 v33, v33
v_exp_f32 v34, v34
v_exp_f32 v35, v35
v_mfma_f32_32x32x16_bf16 v[64:79], a[28:31], v[84:87], v[64:79]
v_exp_f32 v36, v36
v_exp_f32 v37, v37
v_exp_f32 v38, v38
v_exp_f32 v39, v39
s_waitcnt lgkmcnt(4)
v_mfma_f32_32x32x16_bf16 v[16:31], a[0:3], v[128:131], 0
v_exp_f32 v40, v40
v_exp_f32 v41, v41
v_exp_f32 v42, v42
v_exp_f32 v43, v43
v_mfma_f32_32x32x16_bf16 v[16:31], a[4:7], v[136:139], v[16:31]
v_exp_f32 v44, v44
v_exp_f32 v45, v45
v_exp_f32 v46, v46
v_exp_f32 v47, v47
ds_read_b128 a[8:11], v3 offset:2048
ds_read_b128 a[12:15], v4 offset:2048
ds_read_b64_tr_b16 a[24:25], v5 offset:1024
ds_read_b64_tr_b16 a[26:27], v5 offset:1152
ds_read_b64_tr_b16 a[28:29], v5 offset:1280
ds_read_b64_tr_b16 a[30:31], v5 offset:1408
v_cvt_pk_bf16_f32 v88, v32, v33
v_cvt_pk_bf16_f32 v89, v34, v35
v_cvt_pk_bf16_f32 v90, v36, v37
v_cvt_pk_bf16_f32 v91, v38, v39
v_cvt_pk_bf16_f32 v92, v40, v41
v_cvt_pk_bf16_f32 v93, v42, v43
v_cvt_pk_bf16_f32 v94, v44, v45
v_cvt_pk_bf16_f32 v95, v46, v47
s_waitcnt lgkmcnt(6)
v_mfma_f32_32x32x16_bf16 v[64:79], a[32:35], v[88:91], v[64:79]
v_exp_f32 v48, v48
v_exp_f32 v49, v49
v_exp_f32 v50, v50
v_exp_f32 v51, v51
v_mfma_f32_32x32x16_bf16 v[64:79], a[36:39], v[92:95], v[64:79]
v_exp_f32 v52, v52
v_exp_f32 v53, v53
v_exp_f32 v54, v54
v_exp_f32 v55, v55
s_waitcnt lgkmcnt(4)
v_mfma_f32_32x32x16_bf16 v[32:47], a[8:11], v[128:131], 0
v_exp_f32 v56, v56
v_exp_f32 v57, v57
v_exp_f32 v58, v58
v_exp_f32 v59, v59
v_mfma_f32_32x32x16_bf16 v[32:47], a[12:15], v[136:139], v[32:47]
v_exp_f32 v60, v60
v_exp_f32 v61, v61
v_exp_f32 v62, v62
v_exp_f32 v63, v63
ds_read_b128 a[16:19], v3 offset:2560
ds_read_b128 a[20:23], v4 offset:2560
ds_read_b64_tr_b16 a[32:33], v5 offset:1536
ds_read_b64_tr_b16 a[34:35], v5 offset:1664
ds_read_b64_tr_b16 a[36:37], v5 offset:1792
ds_read_b64_tr_b16 a[38:39], v5 offset:1920
v_cvt_pk_bf16_f32 v80, v48, v49
v_cvt_pk_bf16_f32 v81, v50, v51
v_cvt_pk_bf16_f32 v82, v52, v53
v_cvt_pk_bf16_f32 v83, v54, v55
v_cvt_pk_bf16_f32 v84, v56, v57
v_cvt_pk_bf16_f32 v85, v58, v59
v_cvt_pk_bf16_f32 v86, v60, v61
v_cvt_pk_bf16_f32 v87, v62, v63
s_waitcnt lgkmcnt(6)
v_mfma_f32_32x32x16_bf16 v[64:79], a[24:27], v[80:83], v[64:79]
v_exp_f32 v16, v16
v_exp_f32 v17, v17
v_exp_f32 v18, v18
v_exp_f32 v19, v19
v_mfma_f32_32x32x16_bf16 v[64:79], a[28:31], v[84:87], v[64:79]
v_exp_f32 v20, v20
v_exp_f32 v21, v21
v_exp_f32 v22, v22
v_exp_f32 v23, v23
s_waitcnt lgkmcnt(4)
v_mfma_f32_32x32x16_bf16 v[48:63], a[16:19], v[128:131], 0
v_exp_f32 v24, v24
v_exp_f32 v25, v25
v_exp_f32 v26, v26
v_exp_f32 v27, v27
v_mfma_f32_32x32x16_bf16 v[48:63], a[20:23], v[136:139], v[48:63]
v_exp_f32 v28, v28
v_exp_f32 v29, v29
v_exp_f32 v30, v30
v_exp_f32 v31, v31
ds_read_b128 a[0:3], v3 offset:3072
ds_read_b128 a[4:7], v4 offset:3072
ds_read_b64_tr_b16 a[24:25], v5 offset:2048
ds_read_b64_tr_b16 a[26:27], v5 offset:2176
ds_read_b64_tr_b16 a[28:29], v5 offset:2304
ds_read_b64_tr_b16 a[30:31], v5 offset:2432
v_cvt_pk_bf16_f32 v88, v16, v17
v_cvt_pk_bf16_f32 v89, v18, v19
v_cvt_pk_bf16_f32 v90, v20, v21
v_cvt_pk_bf16_f32 v91, v22, v23
v_cvt_pk_bf16_f32 v92, v24, v25
v_cvt_pk_bf16_f32 v93, v26, v27
v_cvt_pk_bf16_f32 v94, v28, v29
v_cvt_pk_bf16_f32 v95, v30, v31
s_waitcnt lgkmcnt(6)
v_mfma_f32_32x32x16_bf16 v[64:79], a[32:35], v[88:91], v[64:79]
v_exp_f32 v32, v32
v_exp_f32 v33, v33
v_exp_f32 v34, v34
v_exp_f32 v35, v35
v_mfma_f32_32x32x16_bf16 v[64:79], a[36:39], v[92:95], v[64:79]
v_exp_f32 v36, v36
v_exp_f32 v37, v37
v_exp_f32 v38, v38
v_exp_f32 v39, v39
s_waitcnt lgkmcnt(4)
v_mfma_f32_32x32x16_bf16 v[16:31], a[0:3], v[128:131], 0
v_exp_f32 v40, v40
v_exp_f32 v41, v41
v_exp_f32 v42, v42
v_exp_f32 v43, v43
v_mfma_f32_32x32x16_bf16 v[16:31], a[4:7], v[136:139], v[16:31]
v_exp_f32 v44, v44
v_exp_f32 v45, v45
v_exp_f32 v46, v46
v_exp_f32 v47, v47
s_cmp_lg_u32 s38, 0
s_cbranch_scc1 L_sbar_24
s_waitcnt vmcnt(3)
s_barrier
L_sbar_24:
ds_read_b128 a[8:11], v3 offset:3584
ds_read_b128 a[12:15], v4 offset:3584
ds_read_b64_tr_b16 a[32:33], v5 offset:2560
ds_read_b64_tr_b16 a[34:35], v5 offset:2688
ds_read_b64_tr_b16 a[36:37], v5 offset:2816
ds_read_b64_tr_b16 a[38:39], v5 offset:2944
v_cvt_pk_bf16_f32 v80, v32, v33
v_cvt_pk_bf16_f32 v81, v34, v35
v_cvt_pk_bf16_f32 v82, v36, v37
v_cvt_pk_bf16_f32 v83, v38, v39
v_cvt_pk_bf16_f32 v84, v40, v41
v_cvt_pk_bf16_f32 v85, v42, v43
v_cvt_pk_bf16_f32 v86, v44, v45
v_cvt_pk_bf16_f32 v87, v46, v47
s_waitcnt lgkmcnt(6)
v_mfma_f32_32x32x16_bf16 v[64:79], a[24:27], v[80:83], v[64:79]
v_exp_f32 v48, v48
v_exp_f32 v49, v49
v_exp_f32 v50, v50
v_exp_f32 v51, v51
v_mfma_f32_32x32x16_bf16 v[64:79], a[28:31], v[84:87], v[64:79]
v_exp_f32 v52, v52
v_exp_f32 v53, v53
v_exp_f32 v54, v54
v_exp_f32 v55, v55
s_waitcnt lgkmcnt(4)
v_mfma_f32_32x32x16_bf16 v[32:47], a[8:11], v[128:131], 0
v_exp_f32 v56, v56
v_exp_f32 v57, v57
v_exp_f32 v58, v58
v_exp_f32 v59, v59
v_mfma_f32_32x32x16_bf16 v[32:47], a[12:15], v[136:139], v[32:47]
v_exp_f32 v60, v60
v_exp_f32 v61, v61
v_exp_f32 v62, v62
v_exp_f32 v63, v63
ds_read_b128 a[16:19], v3 offset:12288
ds_read_b128 a[20:23], v4 offset:6144
ds_read_b64_tr_b16 a[24:25], v5 offset:3072
ds_read_b64_tr_b16 a[26:27], v5 offset:3200
ds_read_b64_tr_b16 a[28:29], v5 offset:3328
ds_read_b64_tr_b16 a[30:31], v5 offset:3456
v_cvt_pk_bf16_f32 v88, v48, v49
v_cvt_pk_bf16_f32 v89, v50, v51
v_cvt_pk_bf16_f32 v90, v52, v53
v_cvt_pk_bf16_f32 v91, v54, v55
v_cvt_pk_bf16_f32 v92, v56, v57
v_cvt_pk_bf16_f32 v93, v58, v59
v_cvt_pk_bf16_f32 v94, v60, v61
v_cvt_pk_bf16_f32 v95, v62, v63
s_waitcnt lgkmcnt(6)
v_mfma_f32_32x32x16_bf16 v[64:79], a[32:35], v[88:91], v[64:79]
v_exp_f32 v16, v16
v_exp_f32 v17, v17
v_exp_f32 v18, v18
v_exp_f32 v19, v19
v_mfma_f32_32x32x16_bf16 v[64:79], a[36:39], v[92:95], v[64:79]
v_exp_f32 v20, v20
v_exp_f32 v21, v21
v_exp_f32 v22, v22
v_exp_f32 v23, v23
s_waitcnt lgkmcnt(4)
v_mfma_f32_32x32x16_bf16 v[48:63], a[16:19], v[132:135], v[160:175]
v_exp_f32 v24, v24
v_exp_f32 v25, v25
v_exp_f32 v26, v26
v_exp_f32 v27, v27
v_mfma_f32_32x32x16_bf16 v[48:63], a[20:23], v[140:143], v[48:63]
v_exp_f32 v28, v28
v_exp_f32 v29, v29
v_exp_f32 v30, v30
v_exp_f32 v31, v31
s_cmp_lg_u32 s38, 0
s_cbranch_scc1 L_sbar_25
s_waitcnt vmcnt(0)
s_barrier
L_sbar_25:
ds_read_b128 a[0:3], v3 offset:12800
ds_read_b128 a[4:7], v4 offset:6656
ds_read_b64_tr_b16 a[32:33], v5 offset:3584
ds_read_b64_tr_b16 a[34:35], v5 offset:3712
ds_read_b64_tr_b16 a[36:37], v5 offset:3840
ds_read_b64_tr_b16 a[38:39], v5 offset:3968
v_cvt_pk_bf16_f32 v80, v16, v17
v_cvt_pk_bf16_f32 v81, v18, v19
v_cvt_pk_bf16_f32 v82, v20, v21
v_cvt_pk_bf16_f32 v83, v22, v23
v_cvt_pk_bf16_f32 v84, v24, v25
v_cvt_pk_bf16_f32 v85, v26, v27
v_cvt_pk_bf16_f32 v86, v28, v29
v_cvt_pk_bf16_f32 v87, v30, v31
s_waitcnt lgkmcnt(6)
v_mfma_f32_32x32x16_bf16 v[64:79], a[24:27], v[80:83], v[64:79]
v_exp_f32 v32, v32
v_exp_f32 v33, v33
v_exp_f32 v34, v34
v_exp_f32 v35, v35
v_mfma_f32_32x32x16_bf16 v[64:79], a[28:31], v[84:87], v[64:79]
v_exp_f32 v36, v36
v_exp_f32 v37, v37
v_exp_f32 v38, v38
v_exp_f32 v39, v39
s_waitcnt lgkmcnt(4)
v_mfma_f32_32x32x16_bf16 v[16:31], a[0:3], v[132:135], 0
v_exp_f32 v40, v40
v_exp_f32 v41, v41
v_exp_f32 v42, v42
v_exp_f32 v43, v43
v_mfma_f32_32x32x16_bf16 v[16:31], a[4:7], v[140:143], v[16:31]
v_exp_f32 v44, v44
v_exp_f32 v45, v45
v_exp_f32 v46, v46
v_exp_f32 v47, v47
ds_read_b128 a[8:11], v3 offset:13312
ds_read_b128 a[12:15], v4 offset:7168
ds_read_b64_tr_b16 a[24:25], v5 offset:18624
ds_read_b64_tr_b16 a[26:27], v5 offset:18752
ds_read_b64_tr_b16 a[28:29], v5 offset:18880
ds_read_b64_tr_b16 a[30:31], v5 offset:19008
s_lshl_b32 s87, s22, 10
s_add_u32 s87, s87, 25600
s_add_u32 m0, s87, 51200
s_nop 0
buffer_load_dwordx4 v241, s[8:11], s87 offen lds
s_lshl_b32 s87, s22, 10
s_add_u32 s87, s87, 29696
s_add_u32 m0, s87, 51200
s_nop 0
buffer_load_dwordx4 v241, s[8:11], s87 offen lds
s_lshl_b32 s87, s22, 10
s_add_u32 s87, s87, 33792
s_add_u32 m0, s87, 51200
s_nop 0
buffer_load_dwordx4 v241, s[8:11], s87 offen lds
buffer_load_dword v237, v15, s[12:15], s90 offen
v_cvt_pk_bf16_f32 v88, v32, v33
v_cvt_pk_bf16_f32 v89, v34, v35
v_cvt_pk_bf16_f32 v90, v36, v37
v_cvt_pk_bf16_f32 v91, v38, v39
v_cvt_pk_bf16_f32 v92, v40, v41
v_cvt_pk_bf16_f32 v93, v42, v43
v_cvt_pk_bf16_f32 v94, v44, v45
v_cvt_pk_bf16_f32 v95, v46, v47
s_waitcnt lgkmcnt(6)
v_mfma_f32_32x32x16_bf16 v[64:79], a[32:35], v[88:91], v[64:79]
v_exp_f32 v48, v48
v_exp_f32 v49, v49
v_exp_f32 v50, v50
v_exp_f32 v51, v51
v_mfma_f32_32x32x16_bf16 v[64:79], a[36:39], v[92:95], v[64:79]
v_exp_f32 v52, v52
v_exp_f32 v53, v53
v_exp_f32 v54, v54
v_exp_f32 v55, v55
s_waitcnt lgkmcnt(4)
v_mfma_f32_32x32x16_bf16 v[32:47], a[8:11], v[132:135], 0
v_exp_f32 v56, v56
v_exp_f32 v57, v57
v_exp_f32 v58, v58
v_exp_f32 v59, v59
v_mfma_f32_32x32x16_bf16 v[32:47], a[12:15], v[140:143], v[32:47]
v_exp_f32 v60, v60
v_exp_f32 v61, v61
v_exp_f32 v62, v62
v_exp_f32 v63, v63
ds_read_b128 a[16:19], v3 offset:13824
ds_read_b128 a[20:23], v4 offset:7680
ds_read_b64_tr_b16 a[32:33], v5 offset:19136
ds_read_b64_tr_b16 a[34:35], v5 offset:19264
ds_read_b64_tr_b16 a[36:37], v5 offset:19392
ds_read_b64_tr_b16 a[38:39], v5 offset:19520
s_lshl_b32 s87, s22, 10
s_add_u32 s87, s87, 37888
s_add_u32 m0, s87, 51200
s_nop 0
buffer_load_dwordx4 v241, s[8:11], s87 offen lds
s_lshl_b32 s87, s22, 10
s_add_u32 s87, s87, 41984
s_add_u32 m0, s87, 51200
s_nop 0
buffer_load_dwordx4 v241, s[8:11], s87 offen lds
s_add_u32 s28, s89, 65536
buffer_load_dword v237, v212, s[80:83], s28 offen
v_cvt_pk_bf16_f32 v80, v48, v49
v_cvt_pk_bf16_f32 v81, v50, v51
v_cvt_pk_bf16_f32 v82, v52, v53
v_cvt_pk_bf16_f32 v83, v54, v55
v_cvt_pk_bf16_f32 v84, v56, v57
v_cvt_pk_bf16_f32 v85, v58, v59
v_cvt_pk_bf16_f32 v86, v60, v61
v_cvt_pk_bf16_f32 v87, v62, v63
s_waitcnt lgkmcnt(6)
v_mfma_f32_32x32x16_bf16 v[96:111], a[24:27], v[80:83], v[96:111]
v_exp_f32 v16, v16
v_exp_f32 v17, v17
v_exp_f32 v18, v18
v_exp_f32 v19, v19
v_mfma_f32_32x32x16_bf16 v[96:111], a[28:31], v[84:87], v[96:111]
v_exp_f32 v20, v20
v_exp_f32 v21, v21
v_exp_f32 v22, v22
v_exp_f32 v23, v23
s_waitcnt lgkmcnt(4)
v_mfma_f32_32x32x16_bf16 v[48:63], a[16:19], v[132:135], 0
v_exp_f32 v24, v24
v_exp_f32 v25, v25
v_exp_f32 v26, v26
v_exp_f32 v27, v27
v_mfma_f32_32x32x16_bf16 v[48:63], a[20:23], v[140:143], v[48:63]
v_exp_f32 v28, v28
v_exp_f32 v29, v29
v_exp_f32 v30, v30
v_exp_f32 v31, v31
ds_read_b128 a[0:3], v3 offset:14336
ds_read_b128 a[4:7], v4 offset:8192
ds_read_b64_tr_b16 a[24:25], v5 offset:19648
ds_read_b64_tr_b16 a[26:27], v5 offset:19776
ds_read_b64_tr_b16 a[28:29], v5 offset:19904
ds_read_b64_tr_b16 a[30:31], v5 offset:20032
s_lshl_b32 s87, s22, 10
s_add_u32 s87, s87, 46080
s_add_u32 m0, s87, 51200
s_nop 0
buffer_load_dwordx4 v241, s[8:11], s87 offen lds
s_lshl_b32 s87, s22, 10
s_add_u32 s87, s87, 50176
s_add_u32 m0, s87, 51200
s_nop 0
buffer_load_dwordx4 v241, s[8:11], s87 offen lds
v_cvt_pk_bf16_f32 v88, v16, v17
v_cvt_pk_bf16_f32 v89, v18, v19
v_cvt_pk_bf16_f32 v90, v20, v21
v_cvt_pk_bf16_f32 v91, v22, v23
v_cvt_pk_bf16_f32 v92, v24, v25
v_cvt_pk_bf16_f32 v93, v26, v27
v_cvt_pk_bf16_f32 v94, v28, v29
v_cvt_pk_bf16_f32 v95, v30, v31
s_waitcnt lgkmcnt(6)
v_mfma_f32_32x32x16_bf16 v[96:111], a[32:35], v[88:91], v[96:111]
v_exp_f32 v32, v32
v_exp_f32 v33, v33
v_exp_f32 v34, v34
v_exp_f32 v35, v35
v_mfma_f32_32x32x16_bf16 v[96:111], a[36:39], v[92:95], v[96:111]
v_exp_f32 v36, v36
v_exp_f32 v37, v37
v_exp_f32 v38, v38
v_exp_f32 v39, v39
s_waitcnt lgkmcnt(4)
v_mfma_f32_32x32x16_bf16 v[16:31], a[0:3], v[132:135], 0
v_exp_f32 v40, v40
v_exp_f32 v41, v41
v_exp_f32 v42, v42
v_exp_f32 v43, v43
v_mfma_f32_32x32x16_bf16 v[16:31], a[4:7], v[140:143], v[16:31]
v_exp_f32 v44, v44
v_exp_f32 v45, v45
v_exp_f32 v46, v46
v_exp_f32 v47, v47
ds_read_b128 a[8:11], v3 offset:14848
ds_read_b128 a[12:15], v4 offset:8704
ds_read_b64_tr_b16 a[32:33], v5 offset:20160
ds_read_b64_tr_b16 a[34:35], v5 offset:20288
ds_read_b64_tr_b16 a[36:37], v5 offset:20416
ds_read_b64_tr_b16 a[38:39], v5 offset:20544
s_lshl_b32 s87, s22, 10
s_add_u32 s87, s87, 54272
s_add_u32 m0, s87, 51200
s_nop 0
buffer_load_dwordx4 v241, s[8:11], s87 offen lds
s_lshl_b32 s87, s22, 10
s_add_u32 s87, s87, 58368
s_add_u32 m0, s87, 51200
s_nop 0
buffer_load_dwordx4 v241, s[8:11], s87 offen lds
s_add_u32 s28, s89, 81920
buffer_load_dword v237, v213, s[80:83], s28 offen
v_cvt_pk_bf16_f32 v80, v32, v33
v_cvt_pk_bf16_f32 v81, v34, v35
v_cvt_pk_bf16_f32 v82, v36, v37
v_cvt_pk_bf16_f32 v83, v38, v39
v_cvt_pk_bf16_f32 v84, v40, v41
v_cvt_pk_bf16_f32 v85, v42, v43
v_cvt_pk_bf16_f32 v86, v44, v45
v_cvt_pk_bf16_f32 v87, v46, v47
s_waitcnt lgkmcnt(6)
v_mfma_f32_32x32x16_bf16 v[96:111], a[24:27], v[80:83], v[96:111]
v_exp_f32 v48, v48
v_exp_f32 v49, v49
v_exp_f32 v50, v50
v_exp_f32 v51, v51
v_mfma_f32_32x32x16_bf16 v[96:111], a[28:31], v[84:87], v[96:111]
v_exp_f32 v52, v52
v_exp_f32 v53, v53
v_exp_f32 v54, v54
v_exp_f32 v55, v55
s_waitcnt lgkmcnt(4)
v_mfma_f32_32x32x16_bf16 v[32:47], a[8:11], v[132:135], 0
v_exp_f32 v56, v56
v_exp_f32 v57, v57
v_exp_f32 v58, v58
v_exp_f32 v59, v59
v_mfma_f32_32x32x16_bf16 v[32:47], a[12:15], v[140:143], v[32:47]
v_exp_f32 v60, v60
v_exp_f32 v61, v61
v_exp_f32 v62, v62
v_exp_f32 v63, v63
ds_read_b128 a[16:19], v3 offset:15360
ds_read_b128 a[20:23], v4 offset:9216
ds_read_b64_tr_b16 a[24:25], v5 offset:20672
ds_read_b64_tr_b16 a[26:27], v5 offset:20800
ds_read_b64_tr_b16 a[28:29], v5 offset:20928
ds_read_b64_tr_b16 a[30:31], v5 offset:21056
s_lshl_b32 s87, s22, 10
s_add_u32 s87, s87, 62464
s_add_u32 m0, s87, 51200
s_nop 0
buffer_load_dwordx4 v241, s[8:11], s87 offen lds
s_lshl_b32 s87, s22, 10
s_add_u32 s87, s87, 66560
s_add_u32 m0, s87, 51200
s_nop 0
buffer_load_dwordx4 v241, s[8:11], s87 offen lds
v_cvt_pk_bf16_f32 v88, v48, v49
v_cvt_pk_bf16_f32 v89, v50, v51
v_cvt_pk_bf16_f32 v90, v52, v53
v_cvt_pk_bf16_f32 v91, v54, v55
v_cvt_pk_bf16_f32 v92, v56, v57
v_cvt_pk_bf16_f32 v93, v58, v59
v_cvt_pk_bf16_f32 v94, v60, v61
v_cvt_pk_bf16_f32 v95, v62, v63
s_waitcnt lgkmcnt(6)
v_mfma_f32_32x32x16_bf16 v[96:111], a[32:35], v[88:91], v[96:111]
v_exp_f32 v16, v16
v_exp_f32 v17, v17
v_exp_f32 v18, v18
v_exp_f32 v19, v19
v_mfma_f32_32x32x16_bf16 v[96:111], a[36:39], v[92:95], v[96:111]
v_exp_f32 v20, v20
v_exp_f32 v21, v21
v_exp_f32 v22, v22
v_exp_f32 v23, v23
s_waitcnt lgkmcnt(4)
v_mfma_f32_32x32x16_bf16 v[48:63], a[16:19], v[132:135], 0
v_exp_f32 v24, v24
v_exp_f32 v25, v25
v_exp_f32 v26, v26
v_exp_f32 v27, v27
v_mfma_f32_32x32x16_bf16 v[48:63], a[20:23], v[140:143], v[48:63]
v_exp_f32 v28, v28
v_exp_f32 v29, v29
v_exp_f32 v30, v30
v_exp_f32 v31, v31
ds_read_b128 a[0:3], v3 offset:15872
ds_read_b128 a[4:7], v4 offset:9728
ds_read_b64_tr_b16 a[32:33], v5 offset:21184
ds_read_b64_tr_b16 a[34:35], v5 offset:21312
ds_read_b64_tr_b16 a[36:37], v5 offset:21440
ds_read_b64_tr_b16 a[38:39], v5 offset:21568
s_lshl_b32 s87, s22, 10
s_add_u32 s87, s87, 70656
s_add_u32 m0, s87, 51200
s_nop 0
buffer_load_dwordx4 v241, s[8:11], s87 offen lds
s_lshl_b32 s87, s22, 10
s_add_u32 s87, s87, 74752
s_add_u32 m0, s87, 51200
s_nop 0
buffer_load_dwordx4 v241, s[8:11], s87 offen lds
s_add_u32 s28, s89, 98304
buffer_load_dword v237, v214, s[80:83], s28 offen
v_cvt_pk_bf16_f32 v80, v16, v17
v_cvt_pk_bf16_f32 v81, v18, v19
v_cvt_pk_bf16_f32 v82, v20, v21
v_cvt_pk_bf16_f32 v83, v22, v23
v_cvt_pk_bf16_f32 v84, v24, v25
v_cvt_pk_bf16_f32 v85, v26, v27
v_cvt_pk_bf16_f32 v86, v28, v29
v_cvt_pk_bf16_f32 v87, v30, v31
s_waitcnt lgkmcnt(6)
v_mfma_f32_32x32x16_bf16 v[96:111], a[24:27], v[80:83], v[96:111]
v_exp_f32 v32, v32
v_exp_f32 v33, v33
v_exp_f32 v34, v34
v_exp_f32 v35, v35
v_mfma_f32_32x32x16_bf16 v[96:111], a[28:31], v[84:87], v[96:111]
v_exp_f32 v36, v36
v_exp_f32 v37, v37
v_exp_f32 v38, v38
v_exp_f32 v39, v39
s_waitcnt lgkmcnt(4)
v_mfma_f32_32x32x16_bf16 v[16:31], a[0:3], v[132:135], 0
v_exp_f32 v40, v40
v_exp_f32 v41, v41
v_exp_f32 v42, v42
v_exp_f32 v43, v43
v_mfma_f32_32x32x16_bf16 v[16:31], a[4:7], v[140:143], v[16:31]
v_exp_f32 v44, v44
v_exp_f32 v45, v45
v_exp_f32 v46, v46
v_exp_f32 v47, v47
ds_read_b64_tr_b16 a[24:25], v5 offset:21696
ds_read_b64_tr_b16 a[26:27], v5 offset:21824
ds_read_b64_tr_b16 a[28:29], v5 offset:21952
ds_read_b64_tr_b16 a[30:31], v5 offset:22080
s_lshl_b32 s87, s22, 10
s_add_u32 s87, s87, 78848
s_add_u32 m0, s87, 51200
s_nop 0
buffer_load_dwordx4 v241, s[8:11], s87 offen lds
s_lshl_b32 s87, s22, 10
s_add_u32 s87, s87, 82944
s_add_u32 m0, s87, 51200
s_nop 0
buffer_load_dwordx4 v241, s[8:11], s87 offen lds
v_cvt_pk_bf16_f32 v88, v32, v33
v_cvt_pk_bf16_f32 v89, v34, v35
v_cvt_pk_bf16_f32 v90, v36, v37
v_cvt_pk_bf16_f32 v91, v38, v39
v_cvt_pk_bf16_f32 v92, v40, v41
v_cvt_pk_bf16_f32 v93, v42, v43
v_cvt_pk_bf16_f32 v94, v44, v45
v_cvt_pk_bf16_f32 v95, v46, v47
s_waitcnt lgkmcnt(4)
v_mfma_f32_32x32x16_bf16 v[96:111], a[32:35], v[88:91], v[96:111]
v_exp_f32 v48, v48
v_exp_f32 v49, v49
v_exp_f32 v50, v50
v_exp_f32 v51, v51
v_mfma_f32_32x32x16_bf16 v[96:111], a[36:39], v[92:95], v[96:111]
v_exp_f32 v52, v52
v_exp_f32 v53, v53
v_exp_f32 v54, v54
v_exp_f32 v55, v55
v_exp_f32 v56, v56
v_exp_f32 v57, v57
v_exp_f32 v58, v58
v_exp_f32 v59, v59
v_exp_f32 v60, v60
v_exp_f32 v61, v61
v_exp_f32 v62, v62
v_exp_f32 v63, v63
ds_read_b64_tr_b16 a[32:33], v5 offset:22208
ds_read_b64_tr_b16 a[34:35], v5 offset:22336
ds_read_b64_tr_b16 a[36:37], v5 offset:22464
ds_read_b64_tr_b16 a[38:39], v5 offset:22592
s_lshl_b32 s87, s22, 10
s_add_u32 s87, s87, 87040
s_add_u32 m0, s87, 51200
s_nop 0
buffer_load_dwordx4 v241, s[8:11], s87 offen lds
s_lshl_b32 s87, s22, 10
s_add_u32 s87, s87, 91136
s_add_u32 m0, s87, 51200
s_nop 0
buffer_load_dwordx4 v241, s[8:11], s87 offen lds
s_add_u32 s28, s89, 114688
buffer_load_dword v237, v215, s[80:83], s28 offen
v_cvt_pk_bf16_f32 v80, v48, v49
v_cvt_pk_bf16_f32 v81, v50, v51
v_cvt_pk_bf16_f32 v82, v52, v53
v_cvt_pk_bf16_f32 v83, v54, v55
v_cvt_pk_bf16_f32 v84, v56, v57
v_cvt_pk_bf16_f32 v85, v58, v59
v_cvt_pk_bf16_f32 v86, v60, v61
v_cvt_pk_bf16_f32 v87, v62, v63
s_waitcnt lgkmcnt(4)
v_mfma_f32_32x32x16_bf16 v[96:111], a[24:27], v[80:83], v[96:111]
v_exp_f32 v16, v16
v_exp_f32 v17, v17
v_exp_f32 v18, v18
v_exp_f32 v19, v19
v_mfma_f32_32x32x16_bf16 v[96:111], a[28:31], v[84:87], v[96:111]
v_exp_f32 v20, v20
v_exp_f32 v21, v21
v_exp_f32 v22, v22
v_exp_f32 v23, v23
v_exp_f32 v24, v24
v_exp_f32 v25, v25
v_exp_f32 v26, v26
v_exp_f32 v27, v27
v_exp_f32 v28, v28
v_exp_f32 v29, v29
v_exp_f32 v30, v30
v_exp_f32 v31, v31
s_lshl_b32 s87, s22, 10
s_add_u32 s87, s87, 95232
s_add_u32 m0, s87, 51200
s_nop 0
buffer_load_dwordx4 v241, s[8:11], s87 offen lds
s_lshl_b32 s87, s22, 10
s_add_u32 s87, s87, 99328
s_min_u32 s87, s87, 101376
s_add_u32 m0, s87, 51200
s_nop 0
buffer_load_dwordx4 v241, s[8:11], s87 offen lds
v_cvt_pk_bf16_f32 v88, v16, v17
v_cvt_pk_bf16_f32 v89, v18, v19
v_cvt_pk_bf16_f32 v90, v20, v21
v_cvt_pk_bf16_f32 v91, v22, v23
v_cvt_pk_bf16_f32 v92, v24, v25
v_cvt_pk_bf16_f32 v93, v26, v27
v_cvt_pk_bf16_f32 v94, v28, v29
v_cvt_pk_bf16_f32 v95, v30, v31
s_waitcnt lgkmcnt(0)
v_mfma_f32_32x32x16_bf16 v[96:111], a[32:35], v[88:91], v[96:111]
v_mfma_f32_32x32x16_bf16 v[96:111], a[36:39], v[92:95], v[96:111]
v_mov_b32 v12, v72
v_mov_b32 v13, v72
s_nop 1
v_permlane32_swap_b32 v12, v13
s_nop 6
v_mov_b32 v14, v104
v_mov_b32 v15, v104
s_nop 1
v_permlane32_swap_b32 v14, v15
v_mov_b32 v11, 0x71800000
v_cmp_nlt_f32 vcc, v13, v11
v_cmp_nlt_f32 s[32:33], v15, v11
s_or_b64 vcc, vcc, s[32:33]
s_cmp_eq_u64 vcc, 0
s_cbranch_scc1 L_smok_27
s_cmp_lg_u32 s38, 0
s_cbranch_scc1 L_smok_27
s_mov_b32 s38, 1
s_nop 7
s_nop 7
v_mov_b32 v138, 0
v_mov_b32 v142, 0
v_mov_b32 v11, 0xff7fffff
ds_read_b128 a[40:43], v3 offset:0
ds_read_b128 a[44:47], v4 offset:0
s_waitcnt lgkmcnt(0)
v_mfma_f32_32x32x16_bf16 v[16:31], a[40:43], v[128:131], v[160:175]
v_mfma_f32_32x32x16_bf16 v[16:31], a[44:47], v[136:139], v[16:31]
s_nop 11
v_max3_f32 v11, v11, v16, v17
v_max3_f32 v11, v11, v18, v19
v_max3_f32 v11, v11, v20, v21
v_max3_f32 v11, v11, v22, v23
v_max3_f32 v11, v11, v24, v25
v_max3_f32 v11, v11, v26, v27
v_max3_f32 v11, v11, v28, v29
v_max3_f32 v11, v11, v30, v31
ds_read_b128 a[40:43], v3 offset:512
ds_read_b128 a[44:47], v4 offset:512
s_waitcnt lgkmcnt(0)
v_mfma_f32_32x32x16_bf16 v[16:31], a[40:43], v[128:131], 0
v_mfma_f32_32x32x16_bf16 v[16:31], a[44:47], v[136:139], v[16:31]
s_nop 11
v_max3_f32 v11, v11, v16, v17
v_max3_f32 v11, v11, v18, v19
v_max3_f32 v11, v11, v20, v21
v_max3_f32 v11, v11, v22, v23
v_max3_f32 v11, v11, v24, v25
v_max3_f32 v11, v11, v26, v27
v_max3_f32 v11, v11, v28, v29
v_max3_f32 v11, v11, v30, v31
ds_read_b128 a[40:43], v3 offset:1024
ds_read_b128 a[44:47], v4 offset:1024
s_waitcnt lgkmcnt(0)
v_mfma_f32_32x32x16_bf16 v[16:31], a[40:43], v[128:131], 0
v_mfma_f32_32x32x16_bf16 v[16:31], a[44:47], v[136:139], v[16:31]
s_nop 11
v_max3_f32 v11, v11, v16, v17
v_max3_f32 v11, v11, v18, v19
v_max3_f32 v11, v11, v20, v21
v_max3_f32 v11, v11, v22, v23
v_max3_f32 v11, v11, v24, v25
v_max3_f32 v11, v11, v26, v27
v_max3_f32 v11, v11, v28, v29
v_max3_f32 v11, v11, v30, v31
ds_read_b128 a[40:43], v3 offset:1536
ds_read_b128 a[44:47], v4 offset:1536
s_waitcnt lgkmcnt(0)
v_mfma_f32_32x32x16_bf16 v[16:31], a[40:43], v[128:131], 0
v_mfma_f32_32x32x16_bf16 v[16:31], a[44:47], v[136:139], v[16:31]
s_nop 11
v_max3_f32 v11, v11, v16, v17
v_max3_f32 v11, v11, v18, v19
v_max3_f32 v11, v11, v20, v21
v_max3_f32 v11, v11, v22, v23
v_max3_f32 v11, v11, v24, v25
v_max3_f32 v11, v11, v26, v27
v_max3_f32 v11, v11, v28, v29
v_max3_f32 v11, v11, v30, v31
ds_read_b128 a[40:43], v3 offset:2048
ds_read_b128 a[44:47], v4 offset:2048
s_waitcnt lgkmcnt(0)
v_mfma_f32_32x32x16_bf16 v[16:31], a[40:43], v[128:131], 0
v_mfma_f32_32x32x16_bf16 v[16:31], a[44:47], v[136:139], v[16:31]
s_nop 11
v_max3_f32 v11, v11, v16, v17
v_max3_f32 v11, v11, v18, v19
v_max3_f32 v11, v11, v20, v21
v_max3_f32 v11, v11, v22, v23
v_max3_f32 v11, v11, v24, v25
v_max3_f32 v11, v11, v26, v27
v_max3_f32 v11, v11, v28, v29
v_max3_f32 v11, v11, v30, v31
ds_read_b128 a[40:43], v3 offset:2560
ds_read_b128 a[44:47], v4 offset:2560
s_waitcnt lgkmcnt(0)
v_mfma_f32_32x32x16_bf16 v[16:31], a[40:43], v[128:131], 0
v_mfma_f32_32x32x16_bf16 v[16:31], a[44:47], v[136:139], v[16:31]
s_nop 11
v_max3_f32 v11, v11, v16, v17
v_max3_f32 v11, v11, v18, v19
v_max3_f32 v11, v11, v20, v21
v_max3_f32 v11, v11, v22, v23
v_max3_f32 v11, v11, v24, v25
v_max3_f32 v11, v11, v26, v27
v_max3_f32 v11, v11, v28, v29
v_max3_f32 v11, v11, v30, v31
ds_read_b128 a[40:43], v3 offset:3072
ds_read_b128 a[44:47], v4 offset:3072
s_waitcnt lgkmcnt(0)
v_mfma_f32_32x32x16_bf16 v[16:31], a[40:43], v[128:131], 0
v_mfma_f32_32x32x16_bf16 v[16:31], a[44:47], v[136:139], v[16:31]
s_nop 11
v_max3_f32 v11, v11, v16, v17
v_max3_f32 v11, v11, v18, v19
v_max3_f32 v11, v11, v20, v21
v_max3_f32 v11, v11, v22, v23
v_max3_f32 v11, v11, v24, v25
v_max3_f32 v11, v11, v26, v27
v_max3_f32 v11, v11, v28, v29
v_max3_f32 v11, v11, v30, v31
ds_read_b128 a[40:43], v3 offset:3584
ds_read_b128 a[44:47], v4 offset:3584
s_waitcnt lgkmcnt(0)
v_mfma_f32_32x32x16_bf16 v[16:31], a[40:43], v[128:131], 0
v_mfma_f32_32x32x16_bf16 v[16:31], a[44:47], v[136:139], v[16:31]
s_nop 11
v_max3_f32 v11, v11, v16, v17
v_max3_f32 v11, v11, v18, v19
v_max3_f32 v11, v11, v20, v21
v_max3_f32 v11, v11, v22, v23
v_max3_f32 v11, v11, v24, v25
v_max3_f32 v11, v11, v26, v27
v_max3_f32 v11, v11, v28, v29
v_max3_f32 v11, v11, v30, v31
ds_read_b128 a[40:43], v3 offset:4096
ds_read_b128 a[44:47], v4 offset:4096
s_waitcnt lgkmcnt(0)
v_mfma_f32_32x32x16_bf16 v[16:31], a[40:43], v[128:131], v[144:159]
v_mfma_f32_32x32x16_bf16 v[16:31], a[44:47], v[136:139], v[16:31]
s_nop 11
v_max3_f32 v11, v11, v16, v17
v_max3_f32 v11, v11, v18, v19
v_max3_f32 v11, v11, v20, v21
v_max3_f32 v11, v11, v22, v23
v_max3_f32 v11, v11, v24, v25
v_max3_f32 v11, v11, v26, v27
v_max3_f32 v11, v11, v28, v29
v_max3_f32 v11, v11, v30, v31
v_mov_b32 v14, 0xff7fffff
ds_read_b128 a[40:43], v3 offset:12288
ds_read_b128 a[44:47], v4 offset:6144
s_waitcnt lgkmcnt(0)
v_mfma_f32_32x32x16_bf16 v[16:31], a[40:43], v[132:135], v[160:175]
v_mfma_f32_32x32x16_bf16 v[16:31], a[44:47], v[140:143], v[16:31]
s_nop 11
v_max3_f32 v14, v14, v16, v17
v_max3_f32 v14, v14, v18, v19
v_max3_f32 v14, v14, v20, v21
v_max3_f32 v14, v14, v22, v23
v_max3_f32 v14, v14, v24, v25
v_max3_f32 v14, v14, v26, v27
v_max3_f32 v14, v14, v28, v29
v_max3_f32 v14, v14, v30, v31
ds_read_b128 a[40:43], v3 offset:12800
ds_read_b128 a[44:47], v4 offset:6656
s_waitcnt lgkmcnt(0)
v_mfma_f32_32x32x16_bf16 v[16:31], a[40:43], v[132:135], 0
v_mfma_f32_32x32x16_bf16 v[16:31], a[44:47], v[140:143], v[16:31]
s_nop 11
v_max3_f32 v14, v14, v16, v17
v_max3_f32 v14, v14, v18, v19
v_max3_f32 v14, v14, v20, v21
v_max3_f32 v14, v14, v22, v23
v_max3_f32 v14, v14, v24, v25
v_max3_f32 v14, v14, v26, v27
v_max3_f32 v14, v14, v28, v29
v_max3_f32 v14, v14, v30, v31
ds_read_b128 a[40:43], v3 offset:13312
ds_read_b128 a[44:47], v4 offset:7168
s_waitcnt lgkmcnt(0)
v_mfma_f32_32x32x16_bf16 v[16:31], a[40:43], v[132:135], 0
v_mfma_f32_32x32x16_bf16 v[16:31], a[44:47], v[140:143], v[16:31]
s_nop 11
v_max3_f32 v14, v14, v16, v17
v_max3_f32 v14, v14, v18, v19
v_max3_f32 v14, v14, v20, v21
v_max3_f32 v14, v14, v22, v23
v_max3_f32 v14, v14, v24, v25
v_max3_f32 v14, v14, v26, v27
v_max3_f32 v14, v14, v28, v29
v_max3_f32 v14, v14, v30, v31
ds_read_b128 a[40:43], v3 offset:13824
ds_read_b128 a[44:47], v4 offset:7680
s_waitcnt lgkmcnt(0)
v_mfma_f32_32x32x16_bf16 v[16:31], a[40:43], v[132:135], 0
v_mfma_f32_32x32x16_bf16 v[16:31], a[44:47], v[140:143], v[16:31]
s_nop 11
v_max3_f32 v14, v14, v16, v17
v_max3_f32 v14, v14, v18, v19
v_max3_f32 v14, v14, v20, v21
v_max3_f32 v14, v14, v22, v23
v_max3_f32 v14, v14, v24, v25
v_max3_f32 v14, v14, v26, v27
v_max3_f32 v14, v14, v28, v29
v_max3_f32 v14, v14, v30, v31
ds_read_b128 a[40:43], v3 offset:14336
ds_read_b128 a[44:47], v4 offset:8192
s_waitcnt lgkmcnt(0)
v_mfma_f32_32x32x16_bf16 v[16:31], a[40:43], v[132:135], 0
v_mfma_f32_32x32x16_bf16 v[16:31], a[44:47], v[140:143], v[16:31]
s_nop 11
v_max3_f32 v14, v14, v16, v17
v_max3_f32 v14, v14, v18, v19
v_max3_f32 v14, v14, v20, v21
v_max3_f32 v14, v14, v22, v23
v_max3_f32 v14, v14, v24, v25
v_max3_f32 v14, v14, v26, v27
v_max3_f32 v14, v14, v28, v29
v_max3_f32 v14, v14, v30, v31
ds_read_b128 a[40:43], v3 offset:14848
ds_read_b128 a[44:47], v4 offset:8704
s_waitcnt lgkmcnt(0)
v_mfma_f32_32x32x16_bf16 v[16:31], a[40:43], v[132:135], 0
v_mfma_f32_32x32x16_bf16 v[16:31], a[44:47], v[140:143], v[16:31]
s_nop 11
v_max3_f32 v14, v14, v16, v17
v_max3_f32 v14, v14, v18, v19
v_max3_f32 v14, v14, v20, v21
v_max3_f32 v14, v14, v22, v23
v_max3_f32 v14, v14, v24, v25
v_max3_f32 v14, v14, v26, v27
v_max3_f32 v14, v14, v28, v29
v_max3_f32 v14, v14, v30, v31
ds_read_b128 a[40:43], v3 offset:15360
ds_read_b128 a[44:47], v4 offset:9216
s_waitcnt lgkmcnt(0)
v_mfma_f32_32x32x16_bf16 v[16:31], a[40:43], v[132:135], 0
v_mfma_f32_32x32x16_bf16 v[16:31], a[44:47], v[140:143], v[16:31]
s_nop 11
v_max3_f32 v14, v14, v16, v17
v_max3_f32 v14, v14, v18, v19
v_max3_f32 v14, v14, v20, v21
v_max3_f32 v14, v14, v22, v23
v_max3_f32 v14, v14, v24, v25
v_max3_f32 v14, v14, v26, v27
v_max3_f32 v14, v14, v28, v29
v_max3_f32 v14, v14, v30, v31
ds_read_b128 a[40:43], v3 offset:15872
ds_read_b128 a[44:47], v4 offset:9728
s_waitcnt lgkmcnt(0)
v_mfma_f32_32x32x16_bf16 v[16:31], a[40:43], v[132:135], 0
v_mfma_f32_32x32x16_bf16 v[16:31], a[44:47], v[140:143], v[16:31]
s_nop 11
v_max3_f32 v14, v14, v16, v17
v_max3_f32 v14, v14, v18, v19
v_max3_f32 v14, v14, v20, v21
v_max3_f32 v14, v14, v22, v23
v_max3_f32 v14, v14, v24, v25
v_max3_f32 v14, v14, v26, v27
v_max3_f32 v14, v14, v28, v29
v_max3_f32 v14, v14, v30, v31
ds_read_b128 a[40:43], v3 offset:16384
ds_read_b128 a[44:47], v4 offset:10240
s_waitcnt lgkmcnt(0)
v_mfma_f32_32x32x16_bf16 v[16:31], a[40:43], v[132:135], v[144:159]
v_mfma_f32_32x32x16_bf16 v[16:31], a[44:47], v[140:143], v[16:31]
s_nop 11
v_max3_f32 v14, v14, v16, v17
v_max3_f32 v14, v14, v18, v19
v_max3_f32 v14, v14, v20, v21
v_max3_f32 v14, v14, v22, v23
v_max3_f32 v14, v14, v24, v25
v_max3_f32 v14, v14, v26, v27
v_max3_f32 v14, v14, v28, v29
v_max3_f32 v14, v14, v30, v31
v_mov_b32 v12, v11
s_nop 1
v_permlane32_swap_b32 v11, v12
v_max_f32 v11, v11, v12
v_and_b32 v12, 0xffff0000, v11
v_sub_f32 v13, v11, v12
v_cvt_pk_bf16_f32 v12, -v12, -v13
v_cndmask_b32 v138, 0, v12, s[66:67]
v_mov_b32 v12, v14
s_nop 1
v_permlane32_swap_b32 v14, v12
v_max_f32 v14, v14, v12
v_and_b32 v12, 0xffff0000, v14
v_sub_f32 v13, v14, v12
v_cvt_pk_bf16_f32 v12, -v12, -v13
v_cndmask_b32 v142, 0, v12, s[68:69]
ds_read_b128 a[40:43], v3 offset:4096
ds_read_b128 a[44:47], v4 offset:4096
s_waitcnt lgkmcnt(0)
v_mfma_f32_32x32x16_bf16 v[16:31], a[40:43], v[128:131], v[144:159]
v_mfma_f32_32x32x16_bf16 v[16:31], a[44:47], v[136:139], v[16:31]
ds_read_b128 a[40:43], v3 offset:16384
ds_read_b128 a[44:47], v4 offset:10240
s_waitcnt lgkmcnt(0)
v_mfma_f32_32x32x16_bf16 v[32:47], a[40:43], v[132:135], v[144:159]
v_mfma_f32_32x32x16_bf16 v[32:47], a[44:47], v[140:143], v[32:47]
v_mov_b32 v6, 0
v_mov_b32 v8, 0
s_nop 15
s_waitcnt lgkmcnt(0)
s_branch L_pass2_21
L_smok_27:
v_rcp_f32 v12, v13
v_rcp_f32 v14, v15
v_mul_f32 v64, v12, v64
v_mul_f32 v65, v12, v65
v_mul_f32 v66, v12, v66
v_mul_f32 v67, v12, v67
v_mul_f32 v68, v12, v68
v_mul_f32 v69, v12, v69
v_mul_f32 v70, v12, v70
v_mul_f32 v71, v12, v71
v_mul_f32 v72, v12, v72
v_mul_f32 v73, v12, v73
v_mul_f32 v74, v12, v74
v_mul_f32 v75, v12, v75
v_cvt_pk_bf16_f32 v112, v64, v65
v_cvt_pk_bf16_f32 v113, v66, v67
v_cvt_pk_bf16_f32 v114, v68, v69
v_cvt_pk_bf16_f32 v115, v70, v71
v_cvt_pk_bf16_f32 v124, v72, v73
v_cvt_pk_bf16_f32 v125, v74, v75
v_mul_f32 v96, v14, v96
v_mul_f32 v97, v14, v97
v_mul_f32 v98, v14, v98
v_mul_f32 v99, v14, v99
v_mul_f32 v100, v14, v100
v_mul_f32 v101, v14, v101
v_mul_f32 v102, v14, v102
v_mul_f32 v103, v14, v103
v_mul_f32 v104, v14, v104
v_mul_f32 v105, v14, v105
v_mul_f32 v106, v14, v106
v_mul_f32 v107, v14, v107
v_cvt_pk_bf16_f32 v120, v96, v97
v_cvt_pk_bf16_f32 v121, v98, v99
v_cvt_pk_bf16_f32 v122, v100, v101
v_cvt_pk_bf16_f32 v123, v102, v103
v_cvt_pk_bf16_f32 v126, v104, v105
v_cvt_pk_bf16_f32 v127, v106, v107
s_mov_b64 s[62:63], exec
s_cmp_eq_u32 s60, 0
s_cbranch_scc1 L_slow_28
buffer_store_dwordx4 v[112:115], v9, s[12:15], s79 offen offset:0
buffer_store_dwordx4 v[120:123], v9, s[12:15], s79 offen offset:768
s_mov_b64 exec, s[66:67]
buffer_store_dwordx4 v[124:127], v10, s[12:15], s79 offen offset:512
s_mov_b64 exec, s[62:63]
s_branch L_dend_29
L_slow_28:
buffer_store_dwordx4 v[112:115], v9, s[12:15], s79 offen offset:0 sc1
buffer_store_dwordx4 v[120:123], v9, s[12:15], s79 offen offset:768 sc1
s_mov_b64 exec, s[66:67]
buffer_store_dwordx4 v[124:127], v10, s[12:15], s79 offen offset:512 sc1
s_mov_b64 exec, s[62:63]
L_dend_29:
s_branch L_attn_done
L_attnA:
s_lshl_b32 s28, s20, 4
s_add_u32 s28, s28, s21
s_lshl_b32 s28, s28, 7
s_add_u32 s28, s28, 32768
v_lshrrev_b32 v7, 2, v0
v_add_u32 v7, 1, v7
v_lshlrev_b32 v7, 11, v7
v_sub_u32 v216, s28, v7
v_and_b32 v7, 3, v0
v_lshlrev_b32 v7, 3, v7
v_add_u32 v216, v216, v7
s_cmp_lg_u32 s22, 0
s_cbranch_scc1 L_epoll_30
s_mov_b64 s[62:63], exec
s_mov_b64 exec, 0xff
buffer_load_dwordx2 v[218:219], v216, s[12:15], 0 offen sc1
s_mov_b64 exec, s[62:63]
L_epoll_30:
v_accvgpr_read_b32 v144, a160
v_accvgpr_read_b32 v145, a161
v_accvgpr_read_b32 v146, a162
v_accvgpr_read_b32 v147, a163
v_accvgpr_read_b32 v148, a164
v_accvgpr_read_b32 v149, a165
v_accvgpr_read_b32 v150, a166
v_accvgpr_read_b32 v151, a167
v_accvgpr_read_b32 v152, a168
v_accvgpr_read_b32 v153, a169
v_accvgpr_read_b32 v154, a170
v_accvgpr_read_b32 v155, a171
v_accvgpr_read_b32 v156, a172
v_accvgpr_read_b32 v157, a173
v_accvgpr_read_b32 v158, a174
v_accvgpr_read_b32 v159, a175
v_accvgpr_read_b32 v160, a176
v_accvgpr_read_b32 v161, a177
v_accvgpr_read_b32 v162, a178
v_accvgpr_read_b32 v163, a179
v_accvgpr_read_b32 v164, a180
v_accvgpr_read_b32 v165, a181
v_accvgpr_read_b32 v166, a182
v_accvgpr_read_b32 v167, a183
v_accvgpr_read_b32 v168, a184
v_accvgpr_read_b32 v169, a185
v_accvgpr_read_b32 v170, a186
v_accvgpr_read_b32 v171, a187
v_accvgpr_read_b32 v172, a188
v_accvgpr_read_b32 v173, a189
v_accvgpr_read_b32 v174, a190
v_accvgpr_read_b32 v175, a191
s_waitcnt lgkmcnt(0)
s_barrier
s_cmp_eq_u32 s22, 0
s_cbranch_scc1 L_kvw0_32
s_branch L_kvaj_33
L_kvw0_32:
L_kvaj_33:
v_mov_b32 v3, v196
v_mov_b32 v4, v197
v_mov_b32 v5, v198
v_mov_b32 v9, v199
v_mov_b32 v10, v211
v_mov_b32 v15, v224
s_mul_i32 s79, s23, 0
s_add_u32 s79, s79, 11534336
s_lshl_b32 s28, s20, 3
s_lshl_b32 s29, s22, 1
s_add_u32 s28, s28, s29
s_mul_i32 s28, s28, 20480
s_add_u32 s79, s79, s28
s_mul_i32 s28, s21, 1280
s_add_u32 s79, s79, s28
s_lshl_b32 s28, s20, 3
s_mul_i32 s28, s28, 20480
s_mul_i32 s29, s21, 1280
s_add_u32 s28, s28, s29
s_add_u32 s90, s28, 11534336
s_cmp_lg_u32 s22, 0
s_cbranch_scc1 L_kvskip2_34
s_add_u32 s24, s23, 2
s_add_u32 s24, s26, s24
s_addc_u32 s25, s27, 0
s_mov_b64 s[62:63], exec
s_min_u32 s29, s20, 1
s_cmp_eq_u32 s29, 0
s_cbranch_scc1 L_kvnp_35
s_mov_b64 exec, 0xc
s_waitcnt vmcnt(0)
v_cmp_ne_u64 vcc, s[24:25], v[218:219]
s_cmp_eq_u64 vcc, 0
s_cbranch_scc1 L_kvnp_35
s_mov_b32 s39, 524288
L_poll_36:
buffer_load_dwordx2 v[218:219], v216, s[12:15], 0 offen sc1
s_waitcnt vmcnt(0)
v_cmp_ne_u64 vcc, s[24:25], v[218:219]
s_cmp_eq_u64 vcc, 0
s_cbranch_scc1 L_pdone_37
s_sub_u32 s39, s39, 1
s_cmp_lg_u32 s39, 0
s_cbranch_scc1 L_poll_36
L_pdone_37:
L_kvnp_35:
s_mov_b64 exec, s[62:63]
L_kvskip2_34:
s_barrier
s_movk_i32 s34, 3072
s_cmp_lt_u32 s20, 1
s_cbranch_scc1 L_fill_38
s_sub_u32 s28, s20, 1
s_lshl_b32 s28, s28, 4
s_add_u32 s28, s28, s21
s_mul_i32 s28, s28, 24576
s_add_u32 s28, s28, s78
s_add_u32 s28, s28, 1024
s_mul_i32 s29, s22, 6144
s_add_u32 s28, s28, s29
s_mov_b32 s31, 6208
s_cmp_lt_u32 s22, 2
s_cselect_b32 s31, 6144, s31
s_mul_i32 s32, s22, 18432
s_sub_u32 s33, s22, 2
s_mul_i32 s33, s33, 18624
s_add_u32 s33, s33, 36864
s_cmp_lt_u32 s22, 2
s_cselect_b32 s32, s32, s33
s_add_u32 s32, s32, s34
s_mov_b32 m0, s32
s_nop 0
buffer_load_dwordx4 v241, s[12:15], s28 offen sc1 lds
s_add_u32 s28, s28, 2048
s_add_u32 s32, s32, s31
s_mov_b32 m0, s32
s_nop 0
buffer_load_dwordx4 v241, s[12:15], s28 offen sc1 lds
s_add_u32 s28, s28, 2048
s_add_u32 s32, s32, s31
s_mov_b32 m0, s32
s_nop 0
buffer_load_dwordx4 v241, s[12:15], s28 offen sc1 lds
s_branch L_fend_39
L_fill_38:
v_mov_b32 v220, 0
v_mov_b32 v221, 0
v_mov_b32 v222, 0
v_mov_b32 v223, 0
v_add_u32 v216, s34, v241
v_add_u32 v217, 36864, v216
ds_write_b128 v216, v[220:223] offset:0
ds_write_b128 v216, v[220:223] offset:6144
ds_write_b128 v216, v[220:223] offset:12288
ds_write_b128 v216, v[220:223] offset:18432
v_mov_b32 v223, 0xF149
ds_write_b128 v216, v[220:223] offset:24576
v_mov_b32 v223, 0
v_mov_b32 v223, 0xF149
ds_write_b128 v216, v[220:223] offset:30720
v_mov_b32 v223, 0
ds_write_b128 v217, v[220:223] offset:0
ds_write_b128 v217, v[220:223] offset:6208
ds_write_b128 v217, v[220:223] offset:12416
ds_write_b128 v217, v[220:223] offset:18624
ds_write_b128 v217, v[220:223] offset:24832
ds_write_b128 v217, v[220:223] offset:31040
L_fend_39:
s_lshl_b32 s87, s22, 10
s_add_u32 s87, s87, 25600
s_add_u32 m0, s87, 51200
s_nop 0
buffer_load_dwordx4 v241, s[8:11], s87 offen lds
s_lshl_b32 s87, s22, 10
s_add_u32 s87, s87, 29696
s_add_u32 m0, s87, 51200
s_nop 0
buffer_load_dwordx4 v241, s[8:11], s87 offen lds
s_lshl_b32 s87, s22, 10
s_add_u32 s87, s87, 33792
s_add_u32 m0, s87, 51200
s_nop 0
buffer_load_dwordx4 v241, s[8:11], s87 offen lds
s_lshl_b32 s87, s22, 10
s_add_u32 s87, s87, 37888
s_add_u32 m0, s87, 51200
s_nop 0
buffer_load_dwordx4 v241, s[8:11], s87 offen lds
s_lshl_b32 s87, s22, 10
s_add_u32 s87, s87, 41984
s_add_u32 m0, s87, 51200
s_nop 0
buffer_load_dwordx4 v241, s[8:11], s87 offen lds
s_lshl_b32 s87, s22, 10
s_add_u32 s87, s87, 46080
s_add_u32 m0, s87, 51200
s_nop 0
buffer_load_dwordx4 v241, s[8:11], s87 offen lds
s_lshl_b32 s87, s22, 10
s_add_u32 s87, s87, 50176
s_add_u32 m0, s87, 51200
s_nop 0
buffer_load_dwordx4 v241, s[8:11], s87 offen lds
s_lshl_b32 s87, s22, 10
s_add_u32 s87, s87, 54272
s_add_u32 m0, s87, 51200
s_nop 0
buffer_load_dwordx4 v241, s[8:11], s87 offen lds
s_lshl_b32 s87, s22, 10
s_add_u32 s87, s87, 58368
s_add_u32 m0, s87, 51200
s_nop 0
buffer_load_dwordx4 v241, s[8:11], s87 offen lds
s_lshl_b32 s87, s22, 10
s_add_u32 s87, s87, 62464
s_add_u32 m0, s87, 51200
s_nop 0
buffer_load_dwordx4 v241, s[8:11], s87 offen lds
s_lshl_b32 s87, s22, 10
s_add_u32 s87, s87, 66560
s_add_u32 m0, s87, 51200
s_nop 0
buffer_load_dwordx4 v241, s[8:11], s87 offen lds
s_lshl_b32 s87, s22, 10
s_add_u32 s87, s87, 70656
s_add_u32 m0, s87, 51200
s_nop 0
buffer_load_dwordx4 v241, s[8:11], s87 offen lds
s_lshl_b32 s87, s22, 10
s_add_u32 s87, s87, 74752
s_add_u32 m0, s87, 51200
s_nop 0
buffer_load_dwordx4 v241, s[8:11], s87 offen lds
s_waitcnt vmcnt(13)
s_waitcnt lgkmcnt(0)
s_barrier
v_mov_b32 v138, 0
v_mov_b32 v142, 0
ds_read_b128 a[40:43], v3 offset:3584
ds_read_b128 a[44:47], v4 offset:3584
ds_read_b128 a[48:51], v3 offset:4096
ds_read_b128 a[52:55], v4 offset:4096
ds_read_b128 a[56:59], v3 offset:15872
ds_read_b128 a[60:63], v4 offset:9728
ds_read_b128 a[64:67], v3 offset:16384
ds_read_b128 a[68:71], v4 offset:10240
buffer_load_dword v237, v15, s[12:15], s90 offen
s_add_u32 s28, s89, 65536
buffer_load_dword v237, v212, s[80:83], s28 offen
s_waitcnt lgkmcnt(6)
v_mfma_f32_32x32x16_bf16 v[16:31], a[40:43], v[128:131], v[160:175]
s_waitcnt lgkmcnt(4)
v_mfma_f32_32x32x16_bf16 v[32:47], a[48:51], v[128:131], v[144:159]
s_waitcnt lgkmcnt(2)
v_mfma_f32_32x32x16_bf16 v[48:63], a[56:59], v[132:135], v[160:175]
s_waitcnt lgkmcnt(0)
v_mfma_f32_32x32x16_bf16 v[96:111], a[64:67], v[132:135], v[144:159]
v_mfma_f32_32x32x16_bf16 v[16:31], a[44:47], v[136:139], v[16:31]
v_mfma_f32_32x32x16_bf16 v[32:47], a[52:55], v[136:139], v[32:47]
v_mfma_f32_32x32x16_bf16 v[48:63], a[60:63], v[140:143], v[48:63]
v_mfma_f32_32x32x16_bf16 v[96:111], a[68:71], v[140:143], v[96:111]
ds_read_b64_tr_b16 a[24:25], v5 offset:3584
ds_read_b64_tr_b16 a[26:27], v5 offset:3712
ds_read_b64_tr_b16 a[28:29], v5 offset:3840
ds_read_b64_tr_b16 a[30:31], v5 offset:3968
v_mov_b32 v11, 0xff7fffff
v_mov_b32 v14, 0xff7fffff
s_nop 2
v_max3_f32 v11, v11, v16, v17
v_max3_f32 v11, v11, v18, v19
v_max3_f32 v11, v11, v20, v21
v_max3_f32 v11, v11, v22, v23
v_max3_f32 v11, v11, v24, v25
v_max3_f32 v11, v11, v26, v27
v_max3_f32 v11, v11, v28, v29
v_max3_f32 v11, v11, v30, v31
v_max3_f32 v11, v11, v32, v33
v_max3_f32 v11, v11, v34, v35
v_max3_f32 v11, v11, v36, v37
v_max3_f32 v11, v11, v38, v39
v_max3_f32 v11, v11, v40, v41
v_max3_f32 v11, v11, v42, v43
v_max3_f32 v11, v11, v44, v45
v_max3_f32 v11, v11, v46, v47
v_max3_f32 v14, v14, v48, v49
v_max3_f32 v14, v14, v50, v51
v_max3_f32 v14, v14, v52, v53
v_max3_f32 v14, v14, v54, v55
v_max3_f32 v14, v14, v56, v57
v_max3_f32 v14, v14, v58, v59
v_max3_f32 v14, v14, v60, v61
v_max3_f32 v14, v14, v62, v63
v_max3_f32 v14, v14, v96, v97
v_max3_f32 v14, v14, v98, v99
v_max3_f32 v14, v14, v100, v101
v_max3_f32 v14, v14, v102, v103
v_max3_f32 v14, v14, v104, v105
v_max3_f32 v14, v14, v106, v107
v_max3_f32 v14, v14, v108, v109
v_max3_f32 v14, v14, v110, v111
v_mov_b32 v13, v11
s_nop 1
v_permlane32_swap_b32 v11, v13
v_max_f32 v11, v11, v13
v_sub_f32 v6, 0, v11
v_mov_b32 v13, v14
s_nop 1
v_permlane32_swap_b32 v14, v13
v_max_f32 v14, v14, v13
v_sub_f32 v12, 0, v14
v_pk_add_f32 v[16:17], v[16:17], v[6:7] op_sel_hi:[1,0]
v_pk_add_f32 v[18:19], v[18:19], v[6:7] op_sel_hi:[1,0]
v_pk_add_f32 v[20:21], v[20:21], v[6:7] op_sel_hi:[1,0]
v_pk_add_f32 v[22:23], v[22:23], v[6:7] op_sel_hi:[1,0]
v_pk_add_f32 v[24:25], v[24:25], v[6:7] op_sel_hi:[1,0]
v_pk_add_f32 v[26:27], v[26:27], v[6:7] op_sel_hi:[1,0]
v_pk_add_f32 v[28:29], v[28:29], v[6:7] op_sel_hi:[1,0]
v_pk_add_f32 v[30:31], v[30:31], v[6:7] op_sel_hi:[1,0]
v_exp_f32 v16, v16
v_exp_f32 v17, v17
v_exp_f32 v18, v18
v_exp_f32 v19, v19
v_exp_f32 v20, v20
v_exp_f32 v21, v21
v_exp_f32 v22, v22
v_exp_f32 v23, v23
v_exp_f32 v24, v24
v_exp_f32 v25, v25
v_exp_f32 v26, v26
v_exp_f32 v27, v27
v_exp_f32 v28, v28
v_exp_f32 v29, v29
v_exp_f32 v30, v30
v_exp_f32 v31, v31
s_lshl_b32 s87, s22, 10
s_add_u32 s87, s87, 78848
s_add_u32 m0, s87, 51200
s_nop 0
buffer_load_dwordx4 v241, s[8:11], s87 offen lds
s_lshl_b32 s87, s22, 10
s_add_u32 s87, s87, 82944
s_add_u32 m0, s87, 51200
s_nop 0
buffer_load_dwordx4 v241, s[8:11], s87 offen lds
ds_read_b64_tr_b16 a[32:33], v5 offset:4096
ds_read_b64_tr_b16 a[34:35], v5 offset:4224
ds_read_b64_tr_b16 a[36:37], v5 offset:4352
ds_read_b64_tr_b16 a[38:39], v5 offset:4480
v_cvt_pk_bf16_f32 v80, v16, v17
v_cvt_pk_bf16_f32 v81, v18, v19
v_cvt_pk_bf16_f32 v82, v20, v21
v_cvt_pk_bf16_f32 v83, v22, v23
v_cvt_pk_bf16_f32 v84, v24, v25
v_cvt_pk_bf16_f32 v85, v26, v27
v_cvt_pk_bf16_f32 v86, v28, v29
v_cvt_pk_bf16_f32 v87, v30, v31
v_pk_add_f32 v[32:33], v[32:33], v[6:7] op_sel_hi:[1,0]
v_pk_add_f32 v[34:35], v[34:35], v[6:7] op_sel_hi:[1,0]
v_pk_add_f32 v[36:37], v[36:37], v[6:7] op_sel_hi:[1,0]
v_pk_add_f32 v[38:39], v[38:39], v[6:7] op_sel_hi:[1,0]
v_pk_add_f32 v[40:41], v[40:41], v[6:7] op_sel_hi:[1,0]
v_pk_add_f32 v[42:43], v[42:43], v[6:7] op_sel_hi:[1,0]
v_pk_add_f32 v[44:45], v[44:45], v[6:7] op_sel_hi:[1,0]
v_pk_add_f32 v[46:47], v[46:47], v[6:7] op_sel_hi:[1,0]
s_waitcnt lgkmcnt(4)
v_mfma_f32_32x32x16_bf16 v[64:79], a[24:27], v[80:83], 0
v_exp_f32 v32, v32
v_exp_f32 v33, v33
v_exp_f32 v34, v34
v_exp_f32 v35, v35
v_exp_f32 v36, v36
v_exp_f32 v37, v37
v_exp_f32 v38, v38
v_exp_f32 v39, v39
v_mfma_f32_32x32x16_bf16 v[64:79], a[28:31], v[84:87], v[64:79]
v_exp_f32 v40, v40
v_exp_f32 v41, v41
v_exp_f32 v42, v42
v_exp_f32 v43, v43
v_exp_f32 v44, v44
v_exp_f32 v45, v45
v_exp_f32 v46, v46
v_exp_f32 v47, v47
s_lshl_b32 s87, s22, 10
s_add_u32 s87, s87, 87040
s_add_u32 m0, s87, 51200
s_nop 0
buffer_load_dwordx4 v241, s[8:11], s87 offen lds
s_lshl_b32 s87, s22, 10
s_add_u32 s87, s87, 91136
s_add_u32 m0, s87, 51200
s_nop 0
buffer_load_dwordx4 v241, s[8:11], s87 offen lds
ds_read_b64_tr_b16 a[24:25], v5 offset:22208
ds_read_b64_tr_b16 a[26:27], v5 offset:22336
ds_read_b64_tr_b16 a[28:29], v5 offset:22464
ds_read_b64_tr_b16 a[30:31], v5 offset:22592
s_add_u32 s28, s89, 81920
buffer_load_dword v237, v213, s[80:83], s28 offen
v_cvt_pk_bf16_f32 v88, v32, v33
v_cvt_pk_bf16_f32 v89, v34, v35
v_cvt_pk_bf16_f32 v90, v36, v37
v_cvt_pk_bf16_f32 v91, v38, v39
v_cvt_pk_bf16_f32 v92, v40, v41
v_cvt_pk_bf16_f32 v93, v42, v43
v_cvt_pk_bf16_f32 v94, v44, v45
v_cvt_pk_bf16_f32 v95, v46, v47
v_pk_add_f32 v[48:49], v[48:49], v[12:13] op_sel_hi:[1,0]
v_pk_add_f32 v[50:51], v[50:51], v[12:13] op_sel_hi:[1,0]
v_pk_add_f32 v[52:53], v[52:53], v[12:13] op_sel_hi:[1,0]
v_pk_add_f32 v[54:55], v[54:55], v[12:13] op_sel_hi:[1,0]
v_pk_add_f32 v[56:57], v[56:57], v[12:13] op_sel_hi:[1,0]
v_pk_add_f32 v[58:59], v[58:59], v[12:13] op_sel_hi:[1,0]
v_pk_add_f32 v[60:61], v[60:61], v[12:13] op_sel_hi:[1,0]
v_pk_add_f32 v[62:63], v[62:63], v[12:13] op_sel_hi:[1,0]
s_waitcnt lgkmcnt(4)
v_mfma_f32_32x32x16_bf16 v[64:79], a[32:35], v[88:91], v[64:79]
v_exp_f32 v48, v48
v_exp_f32 v49, v49
v_exp_f32 v50, v50
v_exp_f32 v51, v51
v_exp_f32 v52, v52
v_exp_f32 v53, v53
v_exp_f32 v54, v54
v_exp_f32 v55, v55
v_mfma_f32_32x32x16_bf16 v[64:79], a[36:39], v[92:95], v[64:79]
v_exp_f32 v56, v56
v_exp_f32 v57, v57
v_exp_f32 v58, v58
v_exp_f32 v59, v59
v_exp_f32 v60, v60
v_exp_f32 v61, v61
v_exp_f32 v62, v62
v_exp_f32 v63, v63
s_lshl_b32 s87, s22, 10
s_add_u32 s87, s87, 95232
s_add_u32 m0, s87, 51200
s_nop 0
buffer_load_dwordx4 v241, s[8:11], s87 offen lds
s_add_u32 s28, s89, 98304
buffer_load_dword v237, v214, s[80:83], s28 offen
s_add_u32 s28, s89, 114688
buffer_load_dword v237, v215, s[80:83], s28 offen
v_cvt_pk_bf16_f32 v80, v48, v49
v_cvt_pk_bf16_f32 v81, v50, v51
v_cvt_pk_bf16_f32 v82, v52, v53
v_cvt_pk_bf16_f32 v83, v54, v55
v_cvt_pk_bf16_f32 v84, v56, v57
v_cvt_pk_bf16_f32 v85, v58, v59
v_cvt_pk_bf16_f32 v86, v60, v61
v_cvt_pk_bf16_f32 v87, v62, v63
v_pk_add_f32 v[96:97], v[96:97], v[12:13] op_sel_hi:[1,0]
v_pk_add_f32 v[98:99], v[98:99], v[12:13] op_sel_hi:[1,0]
v_pk_add_f32 v[100:101], v[100:101], v[12:13] op_sel_hi:[1,0]
v_pk_add_f32 v[102:103], v[102:103], v[12:13] op_sel_hi:[1,0]
v_pk_add_f32 v[104:105], v[104:105], v[12:13] op_sel_hi:[1,0]
v_pk_add_f32 v[106:107], v[106:107], v[12:13] op_sel_hi:[1,0]
v_pk_add_f32 v[108:109], v[108:109], v[12:13] op_sel_hi:[1,0]
v_pk_add_f32 v[110:111], v[110:111], v[12:13] op_sel_hi:[1,0]
v_exp_f32 v96, v96
v_exp_f32 v97, v97
v_exp_f32 v98, v98
v_exp_f32 v99, v99
v_exp_f32 v100, v100
v_exp_f32 v101, v101
v_exp_f32 v102, v102
v_exp_f32 v103, v103
v_exp_f32 v104, v104
v_exp_f32 v105, v105
v_exp_f32 v106, v106
v_exp_f32 v107, v107
v_exp_f32 v108, v108
v_exp_f32 v109, v109
v_exp_f32 v110, v110
v_exp_f32 v111, v111
s_lshl_b32 s87, s22, 10
s_add_u32 s87, s87, 99328
s_min_u32 s87, s87, 101376
s_add_u32 m0, s87, 51200
s_nop 0
buffer_load_dwordx4 v241, s[8:11], s87 offen lds
v_cvt_pk_bf16_f32 v88, v96, v97
v_cvt_pk_bf16_f32 v89, v98, v99
v_cvt_pk_bf16_f32 v90, v100, v101
v_cvt_pk_bf16_f32 v91, v102, v103
v_cvt_pk_bf16_f32 v92, v104, v105
v_cvt_pk_bf16_f32 v93, v106, v107
v_cvt_pk_bf16_f32 v94, v108, v109
v_cvt_pk_bf16_f32 v95, v110, v111
s_waitcnt lgkmcnt(0)
v_mfma_f32_32x32x16_bf16 v[96:111], a[24:27], v[80:83], 0
v_mfma_f32_32x32x16_bf16 v[96:111], a[28:31], v[84:87], v[96:111]
ds_read_b64_tr_b16 a[32:33], v5 offset:22720
ds_read_b64_tr_b16 a[34:35], v5 offset:22848
ds_read_b64_tr_b16 a[36:37], v5 offset:22976
ds_read_b64_tr_b16 a[38:39], v5 offset:23104
s_waitcnt lgkmcnt(0)
v_mfma_f32_32x32x16_bf16 v[96:111], a[32:35], v[88:91], v[96:111]
v_mfma_f32_32x32x16_bf16 v[96:111], a[36:39], v[92:95], v[96:111]
v_mov_b32 v12, v72
v_mov_b32 v13, v72
s_nop 1
v_permlane32_swap_b32 v12, v13
s_nop 6
v_mov_b32 v14, v104
v_mov_b32 v15, v104
s_nop 1
v_permlane32_swap_b32 v14, v15
v_rcp_f32 v12, v13
v_rcp_f32 v14, v15
v_mul_f32 v64, v12, v64
v_mul_f32 v65, v12, v65
v_mul_f32 v66, v12, v66
v_mul_f32 v67, v12, v67
v_mul_f32 v68, v12, v68
v_mul_f32 v69, v12, v69
v_mul_f32 v70, v12, v70
v_mul_f32 v71, v12, v71
v_mul_f32 v72, v12, v72
v_mul_f32 v73, v12, v73
v_mul_f32 v74, v12, v74
v_mul_f32 v75, v12, v75
v_cvt_pk_bf16_f32 v112, v64, v65
v_cvt_pk_bf16_f32 v113, v66, v67
v_cvt_pk_bf16_f32 v114, v68, v69
v_cvt_pk_bf16_f32 v115, v70, v71
v_cvt_pk_bf16_f32 v124, v72, v73
v_cvt_pk_bf16_f32 v125, v74, v75
v_mul_f32 v96, v14, v96
v_mul_f32 v97, v14, v97
v_mul_f32 v98, v14, v98
v_mul_f32 v99, v14, v99
v_mul_f32 v100, v14, v100
v_mul_f32 v101, v14, v101
v_mul_f32 v102, v14, v102
v_mul_f32 v103, v14, v103
v_mul_f32 v104, v14, v104
v_mul_f32 v105, v14, v105
v_mul_f32 v106, v14, v106
v_mul_f32 v107, v14, v107
v_cvt_pk_bf16_f32 v120, v96, v97
v_cvt_pk_bf16_f32 v121, v98, v99
v_cvt_pk_bf16_f32 v122, v100, v101
v_cvt_pk_bf16_f32 v123, v102, v103
v_cvt_pk_bf16_f32 v126, v104, v105
v_cvt_pk_bf16_f32 v127, v106, v107
s_mov_b64 s[62:63], exec
s_cmp_eq_u32 s60, 0
s_cbranch_scc1 L_slow_40
buffer_store_dwordx4 v[112:115], v9, s[12:15], s79 offen offset:0
buffer_store_dwordx4 v[120:123], v9, s[12:15], s79 offen offset:768
s_mov_b64 exec, s[66:67]
buffer_store_dwordx4 v[124:127], v10, s[12:15], s79 offen offset:512
s_mov_b64 exec, s[62:63]
s_branch L_dend_41
L_slow_40:
buffer_store_dwordx4 v[112:115], v9, s[12:15], s79 offen offset:0 sc1
buffer_store_dwordx4 v[120:123], v9, s[12:15], s79 offen offset:768 sc1
s_mov_b64 exec, s[66:67]
buffer_store_dwordx4 v[124:127], v10, s[12:15], s79 offen offset:512 sc1
s_mov_b64 exec, s[62:63]
L_dend_41:
L_attn_done:
s_waitcnt lgkmcnt(0)
s_barrier
s_add_u32 s92, s23, 1
s_and_b32 s28, s92, 1
s_mul_i32 s28, s28, 0x280000
s_mul_i32 s29, s21, 0x28000
s_add_u32 s28, s28, s29
s_add_u32 s28, s28, 52428800
s_add_u32 s4, s56, s28
s_addc_u32 s5, s57, 0
s_cmp_lt_u32 s92, 4
s_cselect_b32 s6, 153600, 0
s_mov_b32 s7, 0x20000
s_lshl_b32 s87, s22, 10
s_add_u32 m0, s87, 51200
s_nop 0
buffer_load_dwordx4 v241, s[8:11], s87 offen lds
s_add_u32 s87, s87, 4096
s_add_u32 m0, s87, 51200
s_nop 0
buffer_load_dwordx4 v241, s[8:11], s87 offen lds
s_add_u32 s87, s87, 4096
s_add_u32 m0, s87, 51200
s_nop 0
buffer_load_dwordx4 v241, s[8:11], s87 offen lds
s_add_u32 s87, s87, 4096
s_add_u32 m0, s87, 51200
s_nop 0
buffer_load_dwordx4 v241, s[8:11], s87 offen lds
s_add_u32 s87, s87, 4096
s_add_u32 m0, s87, 51200
s_nop 0
buffer_load_dwordx4 v241, s[8:11], s87 offen lds
s_add_u32 s87, s87, 4096
s_add_u32 m0, s87, 51200
s_nop 0
buffer_load_dwordx4 v241, s[8:11], s87 offen lds
s_add_u32 s87, s87, 4096
s_min_u32 s87, s87, 24576
s_add_u32 m0, s87, 51200
s_nop 0
buffer_load_dwordx4 v241, s[8:11], s87 offen lds
s_waitcnt vmcnt(7)
s_barrier
s_cmp_eq_u32 s22, 0
s_cbranch_scc1 L_xw0_43
s_cmp_eq_u32 s23, 3
s_cbranch_scc1 L_lastl_44
s_sub_u32 s85, s22, 1
s_lshl_b32 s85, s85, 10
s_add_u32 s85, s85, 0
L_wdl_45:
s_mov_b32 m0, s85
s_nop 0
buffer_load_dwordx4 v241, s[4:7], s85 offen lds
s_add_u32 s85, s85, 3072
s_cmp_lt_u32 s85, 51200
s_cbranch_scc1 L_wdl_45
L_lastl_44:
s_branch L_xskip_42
L_xw0_43:
s_lshl_b32 s28, s20, 7
s_add_u32 s28, s28, 81920
s_add_u32 s24, s64, 8
s_add_u32 s24, s26, s24
s_addc_u32 s25, s27, 0
s_lshl_b32 s29, s21, 3
s_add_u32 s29, s29, s28
s_mov_b64 s[62:63], exec
s_mov_b64 exec, 1
v_mov_b32 v6, s29
v_mov_b32 v8, s24
v_mov_b32 v9, s25
s_cmp_eq_u32 s60, 0
s_cbranch_scc1 L_slow_46
buffer_store_dwordx2 v[8:9], v6, s[12:15], 0 offen
s_branch L_dend_47
L_slow_46:
buffer_store_dwordx2 v[8:9], v6, s[12:15], 0 offen sc1
L_dend_47:
s_mov_b64 exec, 0xffff
v_lshlrev_b32 v6, 3, v0
v_add_u32 v6, s28, v6
v_mov_b32 v10, s25
v_mov_b32 v11, s24
s_mov_b32 s39, 524288
L_poll_48:
buffer_load_dwordx2 v[8:9], v6, s[12:15], 0 offen sc1
s_waitcnt vmcnt(0)
v_sub_co_u32 v8, vcc, v8, v11
s_nop 1
v_subb_co_u32 v9, vcc, v9, v10, vcc
v_cmp_lt_u32 s[30:31], 7, v8
v_cmp_ne_u32 vcc, 0, v9
s_or_b64 vcc, vcc, s[30:31]
s_cmp_eq_u64 vcc, 0
s_cbranch_scc1 L_pdone_49
s_sub_u32 s39, s39, 1
s_cmp_lg_u32 s39, 0
s_cbranch_scc1 L_poll_48
L_pdone_49:
s_mov_b64 exec, s[62:63]
L_xskip_42:
s_add_u32 s64, s64, 1
s_barrier
s_mul_i32 s76, s23, 0
s_add_u32 s76, s76, 11534336
s_lshl_b32 s28, s20, 3
s_lshl_b32 s29, s58, 2
s_add_u32 s28, s28, s29
s_add_u32 s28, s28, s22
s_mul_i32 s28, s28, 20480
s_add_u32 s76, s76, s28
buffer_load_dwordx4 a[0:3], v241, s[12:15], s76 offen offset:0 sc1
buffer_load_dwordx4 a[4:7], v241, s[12:15], s76 offen offset:1024 sc1
buffer_load_dwordx4 a[8:11], v241, s[12:15], s76 offen offset:2048 sc1
buffer_load_dwordx4 a[12:15], v241, s[12:15], s76 offen offset:3072 sc1
s_add_u32 s76, s76, 4096
buffer_load_dwordx4 a[16:19], v241, s[12:15], s76 offen offset:0 sc1
buffer_load_dwordx4 a[20:23], v241, s[12:15], s76 offen offset:1024 sc1
buffer_load_dwordx4 a[24:27], v241, s[12:15], s76 offen offset:2048 sc1
buffer_load_dwordx4 a[28:31], v241, s[12:15], s76 offen offset:3072 sc1
v_lshrrev_b32 v2, 2, v0
v_lshlrev_b32 v2, 10, v2
v_and_b32 v3, 2, v0
v_lshlrev_b32 v3, 8, v3
v_add_u32 v2, v2, v3
v_and_b32 v3, 1, v0
v_lshlrev_b32 v3, 7, v3
v_add_u32 v2, v2, v3
s_lshl_b32 s28, s20, 2
s_lshl_b32 s29, s58, 1
s_add_u32 s28, s28, s29
s_lshr_b32 s29, s22, 1
s_add_u32 s28, s28, s29
s_mul_i32 s28, s28, 40
s_mul_i32 s29, s59, 5
s_add_u32 s28, s28, s29
s_lshl_b32 s28, s28, 10
s_and_b32 s29, s22, 1
s_lshl_b32 s29, s29, 8
s_add_u32 s28, s28, s29
s_add_u32 s28, s28, 1048576
v_add_u32 v2, s28, v2
s_lshl_b32 s28, s20, 1
s_add_u32 s28, s28, s58
s_lshl_b32 s28, s28, 3
s_add_u32 s28, s28, s59
s_lshl_b32 s28, s28, 9
s_lshl_b32 s29, s22, 7
s_add_u32 s28, s28, s29
s_add_u32 s28, s28, 131072
v_mov_b32 v3, s28
v_cmp_gt_u32 vcc, 20, v0
s_nop 1
v_cndmask_b32 v2, v3, v2, vcc
buffer_load_dword v237, v2, s[12:15], 0 offen
s_waitcnt vmcnt(8)
s_barrier
ds_read_b128 v[128:131], v204 offset:0
ds_read_b128 v[132:135], v204 offset:1024
ds_read_b128 v[136:139], v204 offset:2048
ds_read_b128 v[140:143], v204 offset:3072
ds_read_b128 v[144:147], v204 offset:4096
ds_read_b128 v[148:151], v204 offset:5120
ds_read_b128 v[152:155], v204 offset:6144
ds_read_b128 v[156:159], v204 offset:7168
ds_read_b128 v[160:163], v204 offset:8192
ds_read_b128 v[164:167], v204 offset:9216
s_waitcnt vmcnt(8)
s_waitcnt lgkmcnt(5)
v_mfma_f32_16x16x32_bf16 v[64:67], v[128:131], a[0:3], 0
ds_read_b128 v[24:27], v204 offset:10240
v_mfma_f32_16x16x32_bf16 v[68:71], v[132:135], a[0:3], 0
ds_read_b128 v[28:31], v204 offset:11264
s_add_u32 s76, s76, 4096
buffer_load_dwordx4 a[32:35], v241, s[12:15], s76 offen offset:0 sc1
v_mfma_f32_16x16x32_bf16 v[72:75], v[136:139], a[0:3], 0
ds_read_b128 v[32:35], v204 offset:12288
v_mfma_f32_16x16x32_bf16 v[76:79], v[140:143], a[0:3], 0
ds_read_b128 v[36:39], v204 offset:13312
buffer_load_dwordx4 a[36:39], v241, s[12:15], s76 offen offset:1024 sc1
v_mfma_f32_16x16x32_bf16 v[80:83], v[144:147], a[0:3], 0
ds_read_b128 v[40:43], v204 offset:14336
s_waitcnt vmcnt(9)
s_waitcnt lgkmcnt(5)
v_mfma_f32_16x16x32_bf16 v[64:67], v[148:151], a[4:7], v[64:67]
ds_read_b128 v[128:131], v204 offset:15360
v_mfma_f32_16x16x32_bf16 v[68:71], v[152:155], a[4:7], v[68:71]
ds_read_b128 v[132:135], v204 offset:16384
buffer_load_dwordx4 a[40:43], v241, s[12:15], s76 offen offset:2048 sc1
v_mfma_f32_16x16x32_bf16 v[72:75], v[156:159], a[4:7], v[72:75]
ds_read_b128 v[136:139], v204 offset:17408
v_mfma_f32_16x16x32_bf16 v[76:79], v[160:163], a[4:7], v[76:79]
ds_read_b128 v[140:143], v204 offset:18432
buffer_load_dwordx4 a[44:47], v241, s[12:15], s76 offen offset:3072 sc1
v_mfma_f32_16x16x32_bf16 v[80:83], v[164:167], a[4:7], v[80:83]
ds_read_b128 v[144:147], v204 offset:19456
s_waitcnt vmcnt(10)
s_waitcnt lgkmcnt(5)
v_mfma_f32_16x16x32_bf16 v[64:67], v[24:27], a[8:11], v[64:67]
ds_read_b128 v[148:151], v204 offset:20480
v_mfma_f32_16x16x32_bf16 v[68:71], v[28:31], a[8:11], v[68:71]
ds_read_b128 v[152:155], v204 offset:21504
s_add_u32 s76, s76, 4096
buffer_load_dwordx4 a[48:51], v241, s[12:15], s76 offen offset:0 sc1
v_mfma_f32_16x16x32_bf16 v[72:75], v[32:35], a[8:11], v[72:75]
ds_read_b128 v[156:159], v204 offset:22528
v_mfma_f32_16x16x32_bf16 v[76:79], v[36:39], a[8:11], v[76:79]
ds_read_b128 v[160:163], v204 offset:23552
buffer_load_dwordx4 a[52:55], v241, s[12:15], s76 offen offset:1024 sc1
v_mfma_f32_16x16x32_bf16 v[80:83], v[40:43], a[8:11], v[80:83]
ds_read_b128 v[164:167], v204 offset:24576
s_waitcnt vmcnt(11)
s_waitcnt lgkmcnt(5)
v_mfma_f32_16x16x32_bf16 v[64:67], v[128:131], a[12:15], v[64:67]
ds_read_b128 v[24:27], v204 offset:25600
v_mfma_f32_16x16x32_bf16 v[68:71], v[132:135], a[12:15], v[68:71]
ds_read_b128 v[28:31], v204 offset:26624
buffer_load_dwordx4 a[56:59], v241, s[12:15], s76 offen offset:2048 sc1
v_mfma_f32_16x16x32_bf16 v[72:75], v[136:139], a[12:15], v[72:75]
ds_read_b128 v[32:35], v204 offset:27648
v_mfma_f32_16x16x32_bf16 v[76:79], v[140:143], a[12:15], v[76:79]
ds_read_b128 v[36:39], v204 offset:28672
buffer_load_dwordx4 a[60:63], v241, s[12:15], s76 offen offset:3072 sc1
v_mfma_f32_16x16x32_bf16 v[80:83], v[144:147], a[12:15], v[80:83]
ds_read_b128 v[40:43], v204 offset:29696
s_waitcnt vmcnt(12)
s_waitcnt lgkmcnt(5)
v_mfma_f32_16x16x32_bf16 v[64:67], v[148:151], a[16:19], v[64:67]
ds_read_b128 v[128:131], v204 offset:30720
v_mfma_f32_16x16x32_bf16 v[68:71], v[152:155], a[16:19], v[68:71]
ds_read_b128 v[132:135], v204 offset:31744
s_add_u32 s76, s76, 4096
buffer_load_dwordx4 a[64:67], v241, s[12:15], s76 offen offset:0 sc1
v_mfma_f32_16x16x32_bf16 v[72:75], v[156:159], a[16:19], v[72:75]
ds_read_b128 v[136:139], v204 offset:32768
v_mfma_f32_16x16x32_bf16 v[76:79], v[160:163], a[16:19], v[76:79]
ds_read_b128 v[140:143], v204 offset:33792
v_mfma_f32_16x16x32_bf16 v[80:83], v[164:167], a[16:19], v[80:83]
ds_read_b128 v[144:147], v204 offset:34816
s_waitcnt vmcnt(12)
s_waitcnt lgkmcnt(5)
v_mfma_f32_16x16x32_bf16 v[64:67], v[24:27], a[20:23], v[64:67]
ds_read_b128 v[148:151], v204 offset:35840
v_mfma_f32_16x16x32_bf16 v[68:71], v[28:31], a[20:23], v[68:71]
ds_read_b128 v[152:155], v204 offset:36864
buffer_load_dwordx4 a[68:71], v241, s[12:15], s76 offen offset:1024 sc1
v_mfma_f32_16x16x32_bf16 v[72:75], v[32:35], a[20:23], v[72:75]
ds_read_b128 v[156:159], v204 offset:37888
v_mfma_f32_16x16x32_bf16 v[76:79], v[36:39], a[20:23], v[76:79]
ds_read_b128 v[160:163], v204 offset:38912
v_mfma_f32_16x16x32_bf16 v[80:83], v[40:43], a[20:23], v[80:83]
ds_read_b128 v[164:167], v204 offset:39936
s_waitcnt vmcnt(12)
s_waitcnt lgkmcnt(5)
v_mfma_f32_16x16x32_bf16 v[64:67], v[128:131], a[24:27], v[64:67]
ds_read_b128 v[24:27], v204 offset:40960
v_mfma_f32_16x16x32_bf16 v[68:71], v[132:135], a[24:27], v[68:71]
ds_read_b128 v[28:31], v204 offset:41984
buffer_load_dwordx4 a[72:75], v241, s[12:15], s76 offen offset:2048 sc1
v_mfma_f32_16x16x32_bf16 v[72:75], v[136:139], a[24:27], v[72:75]
ds_read_b128 v[32:35], v204 offset:43008
v_mfma_f32_16x16x32_bf16 v[76:79], v[140:143], a[24:27], v[76:79]
ds_read_b128 v[36:39], v204 offset:44032
v_mfma_f32_16x16x32_bf16 v[80:83], v[144:147], a[24:27], v[80:83]
ds_read_b128 v[40:43], v204 offset:45056
s_waitcnt vmcnt(12)
s_waitcnt lgkmcnt(5)
v_mfma_f32_16x16x32_bf16 v[64:67], v[148:151], a[28:31], v[64:67]
ds_read_b128 v[128:131], v204 offset:46080
v_mfma_f32_16x16x32_bf16 v[68:71], v[152:155], a[28:31], v[68:71]
ds_read_b128 v[132:135], v204 offset:47104
buffer_load_dwordx4 a[76:79], v241, s[12:15], s76 offen offset:3072 sc1
v_mfma_f32_16x16x32_bf16 v[72:75], v[156:159], a[28:31], v[72:75]
ds_read_b128 v[136:139], v204 offset:48128
v_mfma_f32_16x16x32_bf16 v[76:79], v[160:163], a[28:31], v[76:79]
ds_read_b128 v[140:143], v204 offset:49152
v_mfma_f32_16x16x32_bf16 v[80:83], v[164:167], a[28:31], v[80:83]
ds_read_b128 v[144:147], v204 offset:50176
s_waitcnt vmcnt(11)
s_waitcnt lgkmcnt(5)
v_mfma_f32_16x16x32_bf16 v[64:67], v[24:27], a[32:35], v[64:67]
ds_read_b128 v[148:151], v204 offset:51200
v_mfma_f32_16x16x32_bf16 v[68:71], v[28:31], a[32:35], v[68:71]
ds_read_b128 v[152:155], v204 offset:52224
v_mfma_f32_16x16x32_bf16 v[72:75], v[32:35], a[32:35], v[72:75]
ds_read_b128 v[156:159], v204 offset:53248
v_mfma_f32_16x16x32_bf16 v[76:79], v[36:39], a[32:35], v[76:79]
ds_read_b128 v[160:163], v204 offset:54272
v_mfma_f32_16x16x32_bf16 v[80:83], v[40:43], a[32:35], v[80:83]
ds_read_b128 v[164:167], v204 offset:55296
s_waitcnt vmcnt(10)
s_waitcnt lgkmcnt(5)
v_mfma_f32_16x16x32_bf16 v[64:67], v[128:131], a[36:39], v[64:67]
ds_read_b128 v[24:27], v204 offset:56320
v_mfma_f32_16x16x32_bf16 v[68:71], v[132:135], a[36:39], v[68:71]
ds_read_b128 v[28:31], v204 offset:57344
v_mfma_f32_16x16x32_bf16 v[72:75], v[136:139], a[36:39], v[72:75]
ds_read_b128 v[32:35], v204 offset:58368
v_mfma_f32_16x16x32_bf16 v[76:79], v[140:143], a[36:39], v[76:79]
ds_read_b128 v[36:39], v204 offset:59392
v_mfma_f32_16x16x32_bf16 v[80:83], v[144:147], a[36:39], v[80:83]
ds_read_b128 v[40:43], v204 offset:60416
s_waitcnt vmcnt(9)
s_waitcnt lgkmcnt(5)
v_mfma_f32_16x16x32_bf16 v[64:67], v[148:151], a[40:43], v[64:67]
ds_read_b128 v[128:131], v205 offset:0
v_mfma_f32_16x16x32_bf16 v[68:71], v[152:155], a[40:43], v[68:71]
ds_read_b128 v[132:135], v205 offset:1024
v_mfma_f32_16x16x32_bf16 v[72:75], v[156:159], a[40:43], v[72:75]
ds_read_b128 v[136:139], v205 offset:2048
v_mfma_f32_16x16x32_bf16 v[76:79], v[160:163], a[40:43], v[76:79]
ds_read_b128 v[140:143], v205 offset:3072
v_mfma_f32_16x16x32_bf16 v[80:83], v[164:167], a[40:43], v[80:83]
ds_read_b128 v[144:147], v205 offset:4096
s_waitcnt vmcnt(8)
s_waitcnt lgkmcnt(5)
v_mfma_f32_16x16x32_bf16 v[64:67], v[24:27], a[44:47], v[64:67]
ds_read_b128 v[148:151], v205 offset:5120
v_mfma_f32_16x16x32_bf16 v[68:71], v[28:31], a[44:47], v[68:71]
ds_read_b128 v[152:155], v205 offset:6144
v_mfma_f32_16x16x32_bf16 v[72:75], v[32:35], a[44:47], v[72:75]
ds_read_b128 v[156:159], v205 offset:7168
v_mfma_f32_16x16x32_bf16 v[76:79], v[36:39], a[44:47], v[76:79]
ds_read_b128 v[160:163], v205 offset:8192
v_mfma_f32_16x16x32_bf16 v[80:83], v[40:43], a[44:47], v[80:83]
ds_read_b128 v[164:167], v205 offset:9216
s_waitcnt vmcnt(7)
s_waitcnt lgkmcnt(5)
v_mfma_f32_16x16x32_bf16 v[64:67], v[128:131], a[48:51], v[64:67]
ds_read_b128 v[24:27], v205 offset:10240
v_mfma_f32_16x16x32_bf16 v[68:71], v[132:135], a[48:51], v[68:71]
ds_read_b128 v[28:31], v205 offset:11264
v_mfma_f32_16x16x32_bf16 v[72:75], v[136:139], a[48:51], v[72:75]
ds_read_b128 v[32:35], v205 offset:12288
v_mfma_f32_16x16x32_bf16 v[76:79], v[140:143], a[48:51], v[76:79]
ds_read_b128 v[36:39], v205 offset:13312
v_mfma_f32_16x16x32_bf16 v[80:83], v[144:147], a[48:51], v[80:83]
ds_read_b128 v[40:43], v205 offset:14336
s_waitcnt vmcnt(6)
s_waitcnt lgkmcnt(5)
v_mfma_f32_16x16x32_bf16 v[64:67], v[148:151], a[52:55], v[64:67]
ds_read_b128 v[128:131], v205 offset:15360
v_mfma_f32_16x16x32_bf16 v[68:71], v[152:155], a[52:55], v[68:71]
ds_read_b128 v[132:135], v205 offset:16384
v_mfma_f32_16x16x32_bf16 v[72:75], v[156:159], a[52:55], v[72:75]
ds_read_b128 v[136:139], v205 offset:17408
v_mfma_f32_16x16x32_bf16 v[76:79], v[160:163], a[52:55], v[76:79]
ds_read_b128 v[140:143], v205 offset:18432
v_mfma_f32_16x16x32_bf16 v[80:83], v[164:167], a[52:55], v[80:83]
ds_read_b128 v[144:147], v205 offset:19456
s_waitcnt vmcnt(5)
s_waitcnt lgkmcnt(5)
v_mfma_f32_16x16x32_bf16 v[64:67], v[24:27], a[56:59], v[64:67]
ds_read_b128 v[148:151], v205 offset:20480
v_mfma_f32_16x16x32_bf16 v[68:71], v[28:31], a[56:59], v[68:71]
ds_read_b128 v[152:155], v205 offset:21504
v_mfma_f32_16x16x32_bf16 v[72:75], v[32:35], a[56:59], v[72:75]
ds_read_b128 v[156:159], v205 offset:22528
v_mfma_f32_16x16x32_bf16 v[76:79], v[36:39], a[56:59], v[76:79]
ds_read_b128 v[160:163], v205 offset:23552
v_mfma_f32_16x16x32_bf16 v[80:83], v[40:43], a[56:59], v[80:83]
ds_read_b128 v[164:167], v205 offset:24576
s_waitcnt vmcnt(4)
s_waitcnt lgkmcnt(5)
v_mfma_f32_16x16x32_bf16 v[64:67], v[128:131], a[60:63], v[64:67]
ds_read_b128 v[24:27], v205 offset:25600
v_mfma_f32_16x16x32_bf16 v[68:71], v[132:135], a[60:63], v[68:71]
ds_read_b128 v[28:31], v205 offset:26624
v_mfma_f32_16x16x32_bf16 v[72:75], v[136:139], a[60:63], v[72:75]
ds_read_b128 v[32:35], v205 offset:27648
s_add_u32 s28, s89, 131072
buffer_load_dword v237, v212, s[80:83], s28 offen
v_mfma_f32_16x16x32_bf16 v[76:79], v[140:143], a[60:63], v[76:79]
ds_read_b128 v[36:39], v205 offset:28672
v_mfma_f32_16x16x32_bf16 v[80:83], v[144:147], a[60:63], v[80:83]
ds_read_b128 v[40:43], v205 offset:29696
s_waitcnt vmcnt(4)
s_waitcnt lgkmcnt(5)
v_mfma_f32_16x16x32_bf16 v[64:67], v[148:151], a[64:67], v[64:67]
ds_read_b128 v[128:131], v205 offset:30720
v_mfma_f32_16x16x32_bf16 v[68:71], v[152:155], a[64:67], v[68:71]
ds_read_b128 v[132:135], v205 offset:31744
v_mfma_f32_16x16x32_bf16 v[72:75], v[156:159], a[64:67], v[72:75]
ds_read_b128 v[136:139], v205 offset:32768
v_mfma_f32_16x16x32_bf16 v[76:79], v[160:163], a[64:67], v[76:79]
ds_read_b128 v[140:143], v205 offset:33792
v_mfma_f32_16x16x32_bf16 v[80:83], v[164:167], a[64:67], v[80:83]
ds_read_b128 v[144:147], v205 offset:34816
s_waitcnt vmcnt(3)
s_waitcnt lgkmcnt(5)
v_mfma_f32_16x16x32_bf16 v[64:67], v[24:27], a[68:71], v[64:67]
ds_read_b128 v[148:151], v205 offset:35840
v_mfma_f32_16x16x32_bf16 v[68:71], v[28:31], a[68:71], v[68:71]
ds_read_b128 v[152:155], v205 offset:36864
v_mfma_f32_16x16x32_bf16 v[72:75], v[32:35], a[68:71], v[72:75]
ds_read_b128 v[156:159], v205 offset:37888
v_mfma_f32_16x16x32_bf16 v[76:79], v[36:39], a[68:71], v[76:79]
ds_read_b128 v[160:163], v205 offset:38912
v_mfma_f32_16x16x32_bf16 v[80:83], v[40:43], a[68:71], v[80:83]
ds_read_b128 v[164:167], v205 offset:39936
s_waitcnt vmcnt(2)
s_waitcnt lgkmcnt(5)
v_mfma_f32_16x16x32_bf16 v[64:67], v[128:131], a[72:75], v[64:67]
v_mfma_f32_16x16x32_bf16 v[68:71], v[132:135], a[72:75], v[68:71]
v_mfma_f32_16x16x32_bf16 v[72:75], v[136:139], a[72:75], v[72:75]
s_add_u32 s28, s89, 147456
buffer_load_dword v237, v213, s[80:83], s28 offen
v_mfma_f32_16x16x32_bf16 v[76:79], v[140:143], a[72:75], v[76:79]
v_mfma_f32_16x16x32_bf16 v[80:83], v[144:147], a[72:75], v[80:83]
s_waitcnt vmcnt(2)
s_waitcnt lgkmcnt(0)
v_mfma_f32_16x16x32_bf16 v[64:67], v[148:151], a[76:79], v[64:67]
v_mfma_f32_16x16x32_bf16 v[68:71], v[152:155], a[76:79], v[68:71]
v_mfma_f32_16x16x32_bf16 v[72:75], v[156:159], a[76:79], v[72:75]
v_mfma_f32_16x16x32_bf16 v[76:79], v[160:163], a[76:79], v[76:79]
v_mfma_f32_16x16x32_bf16 v[80:83], v[164:167], a[76:79], v[80:83]
s_cmp_eq_u32 s23, 3
s_cbranch_scc1 L_final
s_barrier
s_nop 0
v_pk_add_f32 v[44:45], v[176:177], v[64:65]
v_pk_add_f32 v[46:47], v[178:179], v[66:67]
v_pk_add_f32 v[48:49], v[180:181], v[68:69]
s_lshl_b32 s85, s22, 10
s_add_u32 s85, s85, 51200
s_mov_b32 m0, s85
s_nop 0
buffer_load_dwordx4 v241, s[4:7], s85 offen lds
s_add_u32 s85, s85, 4096
v_pk_add_f32 v[50:51], v[182:183], v[70:71]
v_pk_add_f32 v[52:53], v[184:185], v[72:73]
v_pk_add_f32 v[54:55], v[186:187], v[74:75]
s_mov_b32 m0, s85
s_nop 0
buffer_load_dwordx4 v241, s[4:7], s85 offen lds
s_add_u32 s85, s85, 4096
v_pk_add_f32 v[56:57], v[188:189], v[76:77]
v_pk_add_f32 v[58:59], v[190:191], v[78:79]
v_pk_add_f32 v[60:61], v[192:193], v[80:81]
s_mov_b32 m0, s85
s_nop 0
buffer_load_dwordx4 v241, s[4:7], s85 offen lds
s_add_u32 s85, s85, 4096
v_pk_add_f32 v[62:63], v[194:195], v[82:83]
v_cvt_pk_bf16_f32 v16, v44, v45
v_cvt_pk_bf16_f32 v17, v46, v47
v_cvt_pk_bf16_f32 v18, v48, v49
v_cvt_pk_bf16_f32 v19, v50, v51
v_cvt_pk_bf16_f32 v20, v52, v53
v_cvt_pk_bf16_f32 v21, v54, v55
v_cvt_pk_bf16_f32 v22, v56, v57
v_cvt_pk_bf16_f32 v23, v58, v59
v_cvt_pk_bf16_f32 v24, v60, v61
v_cvt_pk_bf16_f32 v25, v62, v63
s_mov_b32 m0, s85
s_nop 0
buffer_load_dwordx4 v241, s[4:7], s85 offen lds
s_add_u32 s85, s85, 4096
s_mov_b32 m0, s85
s_nop 0
buffer_load_dwordx4 v241, s[4:7], s85 offen lds
s_add_u32 s85, s85, 4096
s_add_u32 s23, s23, 1
s_mul_i32 s76, s23, 0
s_add_u32 s76, s76, 1048576
s_mul_i32 s77, s23, 0
s_add_u32 s77, s77, 131072
s_lshl_b32 s28, s20, 2
s_lshl_b32 s29, s58, 1
s_add_u32 s28, s28, s29
s_lshr_b32 s29, s22, 1
s_add_u32 s28, s28, s29
s_mul_i32 s28, s28, 40
s_mul_i32 s29, s59, 5
s_add_u32 s28, s28, s29
s_lshl_b32 s28, s28, 10
s_and_b32 s29, s22, 1
s_lshl_b32 s29, s29, 8
s_add_u32 s28, s28, s29
s_add_u32 s28, s28, s76
s_add_u32 s29, s28, 4096
s_cmp_eq_u32 s60, 0
s_cbranch_scc1 L_slow_50
buffer_store_dwordx2 v[16:17], v249, s[12:15], s28 offen offset:0
buffer_store_dwordx2 v[18:19], v249, s[12:15], s28 offen offset:1024
buffer_store_dwordx2 v[20:21], v249, s[12:15], s28 offen offset:2048
buffer_store_dwordx2 v[22:23], v249, s[12:15], s28 offen offset:3072
buffer_store_dwordx2 v[24:25], v249, s[12:15], s29 offen offset:0
s_branch L_dend_51
L_slow_50:
buffer_store_dwordx2 v[16:17], v249, s[12:15], s28 offen offset:0 sc1
buffer_store_dwordx2 v[18:19], v249, s[12:15], s28 offen offset:1024 sc1
buffer_store_dwordx2 v[20:21], v249, s[12:15], s28 offen offset:2048 sc1
buffer_store_dwordx2 v[22:23], v249, s[12:15], s28 offen offset:3072 sc1
buffer_store_dwordx2 v[24:25], v249, s[12:15], s29 offen offset:0 sc1
L_dend_51:
v_lshlrev_b32 v176, 16, v16
v_and_b32 v177, 0xffff0000, v16
v_lshlrev_b32 v178, 16, v17
v_and_b32 v179, 0xffff0000, v17
v_lshlrev_b32 v180, 16, v18
v_and_b32 v181, 0xffff0000, v18
v_lshlrev_b32 v182, 16, v19
v_and_b32 v183, 0xffff0000, v19
v_lshlrev_b32 v184, 16, v20
v_and_b32 v185, 0xffff0000, v20
v_lshlrev_b32 v186, 16, v21
v_and_b32 v187, 0xffff0000, v21
v_lshlrev_b32 v188, 16, v22
v_and_b32 v189, 0xffff0000, v22
v_lshlrev_b32 v190, 16, v23
v_and_b32 v191, 0xffff0000, v23
v_lshlrev_b32 v192, 16, v24
v_and_b32 v193, 0xffff0000, v24
v_lshlrev_b32 v194, 16, v25
v_and_b32 v195, 0xffff0000, v25
s_mov_b32 m0, s85
s_nop 0
buffer_load_dwordx4 v241, s[4:7], s85 offen lds
s_add_u32 s85, s85, 4096
s_mov_b32 m0, s85
s_nop 0
buffer_load_dwordx4 v241, s[4:7], s85 offen lds
s_add_u32 s85, s85, 4096
v_pk_add_f32 v[8:9], v[176:177], v[178:179]
v_pk_mul_f32 v[10:11], v[176:177], v[176:177]
v_pk_fma_f32 v[10:11], v[178:179], v[178:179], v[10:11]
v_pk_add_f32 v[8:9], v[8:9], v[180:181]
v_pk_fma_f32 v[10:11], v[180:181], v[180:181], v[10:11]
v_pk_add_f32 v[8:9], v[8:9], v[182:183]
v_pk_fma_f32 v[10:11], v[182:183], v[182:183], v[10:11]
v_pk_add_f32 v[8:9], v[8:9], v[184:185]
v_pk_fma_f32 v[10:11], v[184:185], v[184:185], v[10:11]
v_pk_add_f32 v[8:9], v[8:9], v[186:187]
v_pk_fma_f32 v[10:11], v[186:187], v[186:187], v[10:11]
v_pk_add_f32 v[8:9], v[8:9], v[188:189]
v_pk_fma_f32 v[10:11], v[188:189], v[188:189], v[10:11]
v_pk_add_f32 v[8:9], v[8:9], v[190:191]
v_pk_fma_f32 v[10:11], v[190:191], v[190:191], v[10:11]
v_pk_add_f32 v[8:9], v[8:9], v[192:193]
v_pk_fma_f32 v[10:11], v[192:193], v[192:193], v[10:11]
v_pk_add_f32 v[8:9], v[8:9], v[194:195]
v_pk_fma_f32 v[10:11], v[194:195], v[194:195], v[10:11]
v_add_f32 v8, v8, v9
v_add_f32 v9, v10, v11
v_mov_b32 v10, v8
s_nop 1
v_permlane16_swap_b32 v8, v10
v_add_f32 v8, v8, v10
v_mov_b32 v11, v9
s_nop 1
v_permlane16_swap_b32 v9, v11
v_add_f32 v9, v9, v11
v_mov_b32 v10, v8
s_nop 1
v_permlane32_swap_b32 v8, v10
v_add_f32 v8, v8, v10
v_mov_b32 v11, v9
s_nop 1
v_permlane32_swap_b32 v9, v11
v_add_f32 v9, v9, v11
s_lshl_b32 s28, s20, 1
s_add_u32 s28, s28, s58
s_lshl_b32 s28, s28, 3
s_add_u32 s28, s28, s59
s_lshl_b32 s28, s28, 9
s_lshl_b32 s29, s22, 7
s_add_u32 s28, s28, s29
s_add_u32 s28, s28, s77
v_lshlrev_b32 v10, 3, v253
s_mov_b64 s[62:63], exec
s_mov_b64 exec, 0xffff
s_cmp_eq_u32 s60, 0
s_cbranch_scc1 L_slow_52
buffer_store_dwordx2 v[8:9], v10, s[12:15], s28 offen
s_branch L_dend_53
L_slow_52:
buffer_store_dwordx2 v[8:9], v10, s[12:15], s28 offen sc1
L_dend_53:
s_mov_b64 exec, s[62:63]
s_mov_b32 m0, s85
s_nop 0
buffer_load_dwordx4 v241, s[4:7], s85 offen lds
s_add_u32 s85, s85, 4096
s_mov_b32 m0, s85
s_nop 0
buffer_load_dwordx4 v241, s[4:7], s85 offen lds
s_add_u32 s85, s85, 4096
s_mov_b32 m0, s85
s_nop 0
buffer_load_dwordx4 v241, s[4:7], s85 offen lds
s_add_u32 s85, s85, 4096
s_mov_b32 m0, s85
s_nop 0
buffer_load_dwordx4 v241, s[4:7], s85 offen lds
s_add_u32 s85, s85, 4096
s_mov_b32 m0, s85
s_nop 0
buffer_load_dwordx4 v241, s[4:7], s85 offen lds
s_add_u32 s85, s85, 4096
s_mov_b32 m0, s85
s_nop 0
buffer_load_dwordx4 v241, s[4:7], s85 offen lds
s_waitcnt vmcnt(6) lgkmcnt(0)
s_barrier
s_cmp_eq_u32 s22, 0
s_cbranch_scc1 L_xw0_55
s_sub_u32 s85, s22, 1
s_lshl_b32 s85, s85, 10
s_add_u32 s85, s85, 104448
L_wdl_56:
s_mov_b32 m0, s85
s_nop 0
buffer_load_dwordx4 v241, s[4:7], s85 offen lds
s_add_u32 s85, s85, 3072
s_cmp_lt_u32 s85, 122880
s_cbranch_scc1 L_wdl_56
s_branch L_xskip_54
L_xw0_55:
s_lshl_b32 s28, s20, 7
s_add_u32 s28, s28, 81920
s_add_u32 s24, s64, 8
s_add_u32 s24, s26, s24
s_addc_u32 s25, s27, 0
s_lshl_b32 s29, s21, 3
s_add_u32 s29, s29, s28
s_mov_b64 s[62:63], exec
s_mov_b64 exec, 1
v_mov_b32 v6, s29
v_mov_b32 v8, s24
v_mov_b32 v9, s25
s_cmp_eq_u32 s60, 0
s_cbranch_scc1 L_slow_57
buffer_store_dwordx2 v[8:9], v6, s[12:15], 0 offen
s_branch L_dend_58
L_slow_57:
buffer_store_dwordx2 v[8:9], v6, s[12:15], 0 offen sc1
L_dend_58:
s_mov_b64 exec, 0xffff
v_lshlrev_b32 v6, 3, v0
v_add_u32 v6, s28, v6
v_mov_b32 v10, s25
v_mov_b32 v11, s24
s_mov_b32 s39, 524288
L_poll_59:
buffer_load_dwordx2 v[8:9], v6, s[12:15], 0 offen sc1
s_waitcnt vmcnt(0)
v_sub_co_u32 v8, vcc, v8, v11
s_nop 1
v_subb_co_u32 v9, vcc, v9, v10, vcc
v_cmp_lt_u32 s[30:31], 7, v8
v_cmp_ne_u32 vcc, 0, v9
s_or_b64 vcc, vcc, s[30:31]
s_cmp_eq_u64 vcc, 0
s_cbranch_scc1 L_pdone_60
s_sub_u32 s39, s39, 1
s_cmp_lg_u32 s39, 0
s_cbranch_scc1 L_poll_59
L_pdone_60:
s_mov_b64 exec, s[62:63]
L_xskip_54:
s_add_u32 s64, s64, 1
s_barrier
s_branch L_layer
L_final:
s_nop 1
v_pk_add_f32 v[44:45], v[176:177], v[64:65]
v_pk_add_f32 v[46:47], v[178:179], v[66:67]
v_pk_add_f32 v[48:49], v[180:181], v[68:69]
v_pk_add_f32 v[50:51], v[182:183], v[70:71]
v_pk_add_f32 v[52:53], v[184:185], v[72:73]
v_pk_add_f32 v[54:55], v[186:187], v[74:75]
v_pk_add_f32 v[56:57], v[188:189], v[76:77]
v_pk_add_f32 v[58:59], v[190:191], v[78:79]
v_pk_add_f32 v[60:61], v[192:193], v[80:81]
v_pk_add_f32 v[62:63], v[194:195], v[82:83]
v_cvt_pk_bf16_f32 v16, v44, v45
v_cvt_pk_bf16_f32 v17, v46, v47
v_cvt_pk_bf16_f32 v18, v48, v49
v_cvt_pk_bf16_f32 v19, v50, v51
v_cvt_pk_bf16_f32 v20, v52, v53
v_cvt_pk_bf16_f32 v21, v54, v55
v_cvt_pk_bf16_f32 v22, v56, v57
v_cvt_pk_bf16_f32 v23, v58, v59
v_cvt_pk_bf16_f32 v24, v60, v61
v_cvt_pk_bf16_f32 v25, v62, v63
s_mov_b32 s16, s52
s_mov_b32 s17, s53
s_mov_b32 s18, 2621440
s_mov_b32 s19, 0x20000
v_mul_u32_u24 v1, 1280, v253
v_lshlrev_b32 v2, 3, v254
v_add_u32 v1, v1, v2
s_lshl_b32 s28, s20, 7
s_lshl_b32 s29, s58, 6
s_add_u32 s28, s28, s29
s_lshl_b32 s29, s22, 4
s_add_u32 s28, s28, s29
s_mul_i32 s28, s28, 1280
s_mul_i32 s29, s59, 160
s_add_u32 s28, s28, s29
v_mul_u32_u24 v3, 1280, v253
v_and_b32 v4, 1, v254
v_lshlrev_b32 v4, 5, v4
v_add_u32 v3, v3, v4
v_lshrrev_b32 v4, 1, v254
v_lshlrev_b32 v4, 4, v4
v_add_u32 v3, v3, v4
v_permlane16_swap_b32 v16, v18
v_permlane16_swap_b32 v17, v19
v_permlane16_swap_b32 v20, v22
v_permlane16_swap_b32 v21, v23
buffer_store_dwordx4 v[16:19], v3, s[16:19], s28 offen offset:0
buffer_store_dwordx4 v[20:23], v3, s[16:19], s28 offen offset:64
buffer_store_dwordx2 v[24:25], v1, s[16:19], s28 offen offset:128
s_cmp_lg_u32 s22, 0
s_cbranch_scc1 L_nonce_61
v_readfirstlane_b32 s28, v250
s_cmp_lg_u32 s28, 255
s_cbranch_scc1 L_nonce_61
s_add_u32 s24, s26, 64
s_addc_u32 s25, s27, 0
s_mov_b64 exec, 1
v_mov_b32 v6, 0
v_mov_b32 v8, s24
v_mov_b32 v9, s25
buffer_store_dwordx2 v[8:9], v6, s[12:15], 0 offen sc1
L_nonce_61:
L_end:
s_endpgm
L_codeend:
.section .rodata,"a"
.p2align 6
.amdhsa_kernel interleave_layers__sliding_local_dilated__sliding_block__prompt_kernel
  .amdhsa_next_free_vgpr 512
  .amdhsa_next_free_sgpr 102
  .amdhsa_accum_offset 256
  .amdhsa_group_segment_fixed_size 0
  .amdhsa_kernarg_size 72
  .amdhsa_user_sgpr_count 2
  .amdhsa_user_sgpr_kernarg_segment_ptr 1
  .amdhsa_system_sgpr_workgroup_id_x 1
.end_amdhsa_kernel
```
